```python
import torch

def _softmax(x, axis=-1):
    return torch.softmax(x, dim=axis)
def _gelu(x):
    return torch.nn.functional.gelu(x, approximate="tanh")
def _silu(x):
    return torch.nn.functional.silu(x)
def _sigmoid(x):
    return torch.sigmoid(x)
def _layernorm(x, axis=-1, eps=1e-5):
    m = x.mean(dim=axis, keepdim=True)
    v = x.var(dim=axis, keepdim=True, unbiased=False)
    return (x - m) / torch.sqrt(v + eps)
def _scatter_add(tgt, idx, src, axis=0):
    return tgt.clone().index_add_(axis, idx, src)
def _segment_sum(src, seg, n):
    out = torch.zeros((n,) + src.shape[1:], dtype=src.dtype)
    return out.index_add_(0, seg, src)
def _pad(x, pw):
    flat = tuple(v for pair in reversed(pw) for v in pair)
    return torch.nn.functional.pad(x, flat)

kernel_name = 'standalone__ssm_conv_s4d__prompt'

def setup_inputs():

    _w = (lambda a: (lambda t: t.to(torch.bfloat16) if t.is_floating_point() else t)(torch.as_tensor(a)))
    Bsz, L, D, N = 1, 2048, 640, 192
    return {
        "u": _w((lambda *s: torch.randn(*s, dtype=torch.bfloat16) * 0.05)(Bsz, L, D)),
        "log_A_real": _w((lambda *s: torch.randn(*s, dtype=torch.bfloat16) * 6.4)(D, N) * 0.5),
        "A_imag": _w((lambda *s: torch.randn(*s, dtype=torch.bfloat16) * 0.05)(D, N) * 3.14),
        "C_real": _w((lambda *s: torch.randn(*s, dtype=torch.bfloat16) * 0.05)(D, N) / N ** 0.5),
        "C_imag": _w((lambda *s: torch.randn(*s, dtype=torch.bfloat16) * 0.05)(D, N) / N ** 0.5),
        "log_dt": _w((lambda *s: torch.randn(*s, dtype=torch.bfloat16) * 0.05)(D) * 0.5 - 4.0),
        "D_skip": _w((lambda *s: torch.randn(*s, dtype=torch.bfloat16) * 0.05)(D)),
    }

def reference(u, log_A_real, A_imag, C_real, C_imag, log_dt, D_skip):
    L = u.shape[1]
    dt = torch.exp(log_dt)
    A = -torch.exp(log_A_real) + 1j * A_imag
    C = (C_real + 1j * C_imag) * dt[:, None]
    pos = (lambda x, dt: x.to(dt))(torch.arange(L), log_dt.dtype)
    P = torch.exp((A * dt[:, None])[:, :, None] * pos[None, None, :])
    K = 2.0 * torch.einsum("dn,dnl->dl", C, P).real
    L2 = 2 * L
    u_t = (lambda x, *d: x.permute(*d))(u, 0, 2, 1)
    Kf = (lambda x, *a, **k: torch.fft.rfft(x.float(), *a, **k))(K, L2)
    Uf = (lambda x, *a, **k: torch.fft.rfft(x.float(), *a, **k))(u_t, L2)
    y = (lambda x, *a, **k: torch.fft.irfft(x, *a, **k).to(torch.bfloat16))(Uf * Kf[None, :, :], L2)[:, :, :L]
    y = (lambda x, *d: x.permute(*d))(y, 0, 2, 1)
    return y + u * D_skip[None, None, :]
```

```asm
; @launch grid=(256,1,1) block=(1024,1,1) lds=163840
.amdgcn_target "amdgcn-amd-amdhsa--gfx950"
.text
.globl standalone__ssm_conv_s4d__prompt_kernel
.p2align 8
.type standalone__ssm_conv_s4d__prompt_kernel,@function
standalone__ssm_conv_s4d__prompt_kernel:
    s_load_dwordx16 s[16:31], s[0:1], 0

    s_getpc_b64 s[62:63]
    v_and_b32 v1, 63, v0
    v_lshrrev_b32 v2, 6, v0
    s_nop 0
    v_readfirstlane_b32 s3, v2
    v_subrev_u32 v4, 768, v0
    v_lshlrev_b32 v3, 7, v4
    v_cmp_gt_u32 vcc, 0x6e, v4
    s_and_saveexec_b64 s[44:45], vcc
    s_nop 2
    s_cbranch_execz L_nopf
    global_load_dword v127, v3, s[62:63]
L_nopf:
    s_mov_b64 exec, -1

    s_cmp_lt_u32 s2, 160
    s_cbranch_scc1 L_main
L_pref:
    s_cmp_ge_u32 s2, 256
    s_cbranch_scc1 L_pfend
    s_and_b32 s4, s2, 7
    s_sub_u32 s5, s2, 160
    s_lshr_b32 s5, s5, 3
    s_mul_i32 s6, s5, 342
    v_add_u32 v2, s6, v0
    v_lshrrev_b32 v3, 1, v2
    v_and_b32_e64 v4, 1, v2
    v_mul_u32_u24 v3, 1280, v3
    v_lshl_add_u32 v3, v4, 7, v3
    s_mul_i32 s7, s4, 160
    s_and_b32 s7, s7, 0xffffff80
    s_waitcnt lgkmcnt(0)
    s_mov_b32 s36, s16
    s_and_b32 s37, s17, 0xffff
    s_mov_b32 s38, 2621440
    s_mov_b32 s39, 0x20000
    v_cmp_gt_u32 vcc, 342, v0
    s_and_saveexec_b64 s[44:45], vcc
    s_nop 2
    s_cbranch_execz L_pfend
    buffer_load_dword v5, v3, s[36:39], s7 offen
L_pfend:
    s_endpgm
L_main:
    s_and_b32 s4, s2, 7
    s_lshr_b32 s5, s2, 3
    s_mul_i32 s4, s4, 20
    s_add_u32 s4, s4, s5
    s_lshl_b32 s5, s4, 2
    s_and_b32 s6, s3, 3
    s_lshr_b32 s7, s3, 2
    s_add_u32 s8, s5, s6
    v_mov_b32 v4, 0
    v_mov_b32 v5, 0
    v_mov_b32 v6, 0
    v_mov_b32 v7, 0
    s_cmp_lt_u32 s3, 12
    s_cbranch_scc1 L_kgen
    s_lshl_b32 s9, s6, 6
    v_add_u32 v8, s9, v1
    v_lshrrev_b32 v9, 2, v8
    v_and_b32 v10, 3, v8
    v_lshl_add_u32 v9, v9, 3, v10
    v_mul_u32_u24 v9, 5120, v9
    s_lshl_b32 s10, s5, 1
    v_add_u32 v9, s10, v9
    s_lshl_b32 s11, s5, 1
    v_mov_b32 v10, s11
    s_waitcnt lgkmcnt(0)
    s_mov_b32 s36, s16
    s_and_b32 s37, s17, 0xffff
    s_mov_b32 s38, 2621440
    s_mov_b32 s39, 0x20000
    s_mov_b32 s40, s30
    s_and_b32 s41, s31, 0xffff
    s_mov_b32 s42, 2621440
    s_mov_b32 s43, 0x20000
    s_mov_b32 s12, 20480
    v_mov_b32 v12, 158208
    v_lshl_add_u32 v13, v1, 4, v12
    s_mov_b32 exec_hi, 0
    ds_write_b128 v13, v[4:7]
    s_mov_b64 exec, -1
    s_waitcnt lgkmcnt(0)
    s_barrier
    buffer_load_dwordx2 v[16:17], v9, s[36:39], 0 offen offset:0
    buffer_load_dwordx2 v[18:19], v9, s[36:39], 0 offen offset:1280
    buffer_load_dwordx2 v[20:21], v9, s[36:39], 0 offen offset:2560
    buffer_load_dwordx2 v[22:23], v9, s[36:39], 0 offen offset:3840
    s_branch L_uwave
L_shr:
    v_lshlrev_b32 v16, 16, v16
    v_mul_f32 v24, s13, v16
    v_rndne_f32 v25, v24
    v_sub_f32 v24, v24, v25
    v_fma_f32 v24, v16, s14, v24
    v_exp_f32 v24, v24
    v_cvt_i32_f32 v25, v25
    v_ldexp_f32 v24, v24, v25
    v_cvt_pk_bf16_f32 v24, v24, v24
    v_lshlrev_b32 v16, 16, v24
    s_nop 1
L_shrspin:
    ds_read_b128 v[20:23], v124
    s_waitcnt lgkmcnt(0)
    v_readfirstlane_b32 s40, v23
    v_readfirstlane_b32 s38, v22
    s_cmp_eq_u32 s40, 0
    s_nop 2
    s_cbranch_scc1 L_shrspin
    s_branch L_shrdone
L_kgen:
    s_mul_i32 s9, s8, 384
    s_lshl_b32 s10, s7, 7
    v_lshl_add_u32 v9, v1, 1, s9
    v_add_u32 v9, s10, v9
    v_min_u32 v8, 47, v1
    v_lshl_add_u32 v8, v8, 3, s9
    s_lshl_b32 s11, s8, 1
    v_mov_b32 v10, s11
    s_waitcnt lgkmcnt(0)
    global_load_ushort v16, v9, s[18:19]
    global_load_ushort v17, v9, s[20:21]
    global_load_ushort v18, v9, s[22:23]
    global_load_ushort v19, v9, s[24:25]
    s_cmp_lg_u32 s7, 0
    s_cbranch_scc1 L_skipld
    global_load_ushort v20, v10, s[26:27]
    global_load_dwordx2 v[22:23], v8, s[22:23]
    global_load_dwordx2 v[24:25], v8, s[24:25]
L_skipld:
    s_barrier
    s_mul_i32 s46, s6, 9984
    s_add_u32 s46, s46, 54912
    s_mul_i32 s15, s7, 1648
    s_add_u32 s15, s15, s46
    v_lshl_add_u32 v3, v1, 4, s15
    ds_write_b128 v3, v[4:7]
    ds_write_b128 v3, v[4:7] offset:672
    s_mul_i32 s12, s3, 4576
    s_mov_b32 m0, s12
    v_and_b32 v2, 15, v1
    v_lshrrev_b32 v3, 4, v1
    v_mul_u32_u24 v13, 288, v2
    v_lshl_add_u32 v13, v3, 4, v13
    v_add_u32 v13, s12, v13
    v_lshlrev_b32 v26, 5, v2
    v_lshl_add_u32 v27, v3, 4, v26
    v_lshl_add_u32 v26, v3, 3, v26
    v_sub_u32 v26, 1144, v26
    v_add_u32_e64 v126, s46, v26
    v_sub_u32 v27, 626, v27
    v_mov_b32 v26, 114
    v_cmp_eq_u32 vcc, 32, v1
    s_nop 1
    v_cndmask_b32 v27, v27, v26, vcc
    v_add_u32 v125, s46, v27
    s_lshl_b32 s15, s6, 2
    s_add_u32 s15, s15, 158208
    v_mov_b32 v3, s15
    s_lshl_b32 s15, s6, 4
    s_add_u32 s15, s15, 158464
    v_mov_b32 v124, s15
    s_mov_b32 s13, 0x3fb8aa00
    s_mov_b32 s14, 0x36eca570
    s_waitcnt vmcnt(0)
    v_mov_b32 v10, v126
    v_mov_b32 v11, v125
    s_cmp_lg_u32 s7, 0
    s_cbranch_scc1 L_shr
    s_mov_b32 s15, 0x7fff7fff
    v_and_b32 v22, s15, v22
    v_and_b32 v23, s15, v23
    v_and_b32 v24, s15, v24
    v_and_b32_e64 v25, s15, v25
    v_pk_max_u16 v22, v22, v23
    v_pk_max_u16 v24, v24, v25
    v_pk_max_u16 v22, v22, v24
    v_lshrrev_b32_e64 v21, 16, v22
    v_and_b32 v22, 0xffff, v22
    v_max_u32 v21, v21, v22
    v_lshlrev_b32 v16, 16, v16
    v_lshlrev_b32_e64 v20, 16, v20
    v_max_u32_dpp v21, v21, v21 row_shr:1 row_mask:0xf bank_mask:0xf
    v_mul_f32 v22, s13, v20
    v_rndne_f32 v23, v22
    v_sub_f32_e64 v22, v22, v23
    v_max_u32_dpp v21, v21, v21 row_shr:2 row_mask:0xf bank_mask:0xf
    v_fma_f32 v22, v20, s14, v22
    v_exp_f32 v22, v22
    v_cvt_i32_f32 v23, v23
    v_max_u32_dpp v21, v21, v21 row_shr:4 row_mask:0xf bank_mask:0xf
    v_ldexp_f32 v22, v22, v23
    v_cvt_pk_bf16_f32 v22, v22, v22
    v_lshlrev_b32_e64 v20, 16, v22
    v_max_u32_dpp v21, v21, v21 row_shr:8 row_mask:0xf bank_mask:0xf
    v_mul_f32 v24, s13, v16
    v_rndne_f32 v25, v24
    v_sub_f32_e64 v24, v24, v25
    v_max_u32_dpp v21, v21, v21 row_bcast:15 row_mask:0xa bank_mask:0xf
    v_fma_f32 v24, v16, s14, v24
    v_exp_f32 v24, v24
    v_cvt_i32_f32 v25, v25
    v_max_u32_dpp v21, v21, v21 row_bcast:31 row_mask:0xc bank_mask:0xf
    v_ldexp_f32 v24, v24, v25
    v_cvt_pk_bf16_f32 v24, v24, v24
    v_lshlrev_b32_e64 v16, 16, v24
    v_readlane_b32 s36, v21, 63
    v_readfirstlane_b32 s37, v20
    s_lshr_b32 s36, s36, 7
    s_lshr_b32 s37, s37, 23
    s_sub_i32 s38, 194, s37
    s_max_i32 s36, s36, s38
    s_sub_u32 s38, 133, s36
    s_sub_u32 s39, 126, s37
    s_add_u32 s40, s36, s37
    s_sub_u32 s40, 1282, s40
    v_ldexp_f32 v21, v20, s39
    v_mov_b32 v22, s38
    v_mov_b32 v23, s40
    s_mov_b32 exec_lo, 1
    s_mov_b32 exec_hi, 0
    ds_write_b128 v124, v[20:23]
    s_mov_b64 exec, -1
L_shrdone:
    v_lshlrev_b32 v17, 16, v17
    v_lshlrev_b32 v18, 16, v18
    v_lshlrev_b32_e64 v19, 16, v19
    s_sub_u32 s40, s40, 1024
    v_mul_f32 v16, v16, v20
    v_mul_f32 v17, v17, v20
    v_ldexp_f32 v18, v18, s38
    v_ldexp_f32 v19, v19, s38
    s_mov_b32 s41, 0x3fb8aa3b
    s_mov_b32 s42, 0x3e22f983
    s_mov_b32 s43, 0x31dc9c88
    v_mul_f32 v32, v18, v21
    v_mul_f32 v33, v19, v21
    v_mul_f32 v16, s41, v16
    v_mul_f32_e64 v18, s42, v17
    v_fma_f32 v19, v17, s42, -v18
    v_fma_f32 v19, v17, s43, v19
    v_mul_f32 v30, 0xc1800000, v16
    v_mul_f32 v31, 0x41800000, v18
    v_exp_f32 v30, v30
    v_fract_f32 v31, v31
    v_mul_f32 v22, 0x41800000, v19
    v_add_f32 v31, v31, v22
    v_cos_f32 v22, v31
    v_sin_f32 v23, v31
    v_mul_f32 v22, v22, v30
    v_mul_f32_e64 v23, v23, v30
    v_exp_f32 v14, -v16
    v_fract_f32 v15, v18
    v_add_f32 v15, v15, v19
    v_cos_f32 v20, v15
    v_sin_f32 v21, v15
    v_mul_f32 v20, v20, v14
    v_mul_f32 v21, v21, v14
    v_mov_b32 v15, 0x3c00
    ds_write_addtid_b32 v15
    v_cvt_pk_f16_f32 v8, v22, v23
    ds_write_addtid_b32 v8 offset:288
    v_pk_mul_f32 v[34:35], v[32:33], v[20:21] op_sel:[0,0] op_sel_hi:[0,1]
    v_pk_fma_f32 v[34:35], v[32:33], v[20:21], v[34:35] op_sel:[1,1,0] op_sel_hi:[1,0,1] neg_lo:[1,0,0]
    v_pk_mul_f32 v[68:69], v[22:23], v[22:23] op_sel:[0,0] op_sel_hi:[0,1]
    v_pk_fma_f32 v[68:69], v[22:23], v[22:23], v[68:69] op_sel:[1,1,0] op_sel_hi:[1,0,1] neg_lo:[1,0,0]
    v_pk_mul_f32 v[36:37], v[34:35], v[20:21] op_sel:[0,0] op_sel_hi:[0,1]
    v_pk_fma_f32 v[36:37], v[34:35], v[20:21], v[36:37] op_sel:[1,1,0] op_sel_hi:[1,0,1] neg_lo:[1,0,0]
    v_cvt_pk_f16_f32 v9, v68, v69
    ds_write_addtid_b32 v9 offset:576
    v_pk_mul_f32 v[70:71], v[68:69], v[22:23] op_sel:[0,0] op_sel_hi:[0,1]
    v_pk_fma_f32 v[70:71], v[68:69], v[22:23], v[70:71] op_sel:[1,1,0] op_sel_hi:[1,0,1] neg_lo:[1,0,0]
    v_pk_mul_f32 v[38:39], v[36:37], v[20:21] op_sel:[0,0] op_sel_hi:[0,1]
    v_pk_fma_f32 v[38:39], v[36:37], v[20:21], v[38:39] op_sel:[1,1,0] op_sel_hi:[1,0,1] neg_lo:[1,0,0]
    v_cvt_pk_f16_f32 v12, v70, v71
    ds_write_addtid_b32 v12 offset:864
    v_pk_mul_f32 v[72:73], v[70:71], v[22:23] op_sel:[0,0] op_sel_hi:[0,1]
    v_pk_fma_f32 v[72:73], v[70:71], v[22:23], v[72:73] op_sel:[1,1,0] op_sel_hi:[1,0,1] neg_lo:[1,0,0]
    v_pk_mul_f32 v[40:41], v[38:39], v[20:21] op_sel:[0,0] op_sel_hi:[0,1]
    v_pk_fma_f32 v[40:41], v[38:39], v[20:21], v[40:41] op_sel:[1,1,0] op_sel_hi:[1,0,1] neg_lo:[1,0,0]
    v_cvt_pk_f16_f32 v14, v72, v73
    ds_write_addtid_b32 v14 offset:1152
    v_pk_mul_f32 v[74:75], v[72:73], v[22:23] op_sel:[0,0] op_sel_hi:[0,1]
    v_pk_fma_f32 v[74:75], v[72:73], v[22:23], v[74:75] op_sel:[1,1,0] op_sel_hi:[1,0,1] neg_lo:[1,0,0]
    v_pk_mul_f32 v[42:43], v[40:41], v[20:21] op_sel:[0,0] op_sel_hi:[0,1]
    v_pk_fma_f32 v[42:43], v[40:41], v[20:21], v[42:43] op_sel:[1,1,0] op_sel_hi:[1,0,1] neg_lo:[1,0,0]
    v_cvt_pk_f16_f32 v8, v74, v75
    ds_write_addtid_b32 v8 offset:1440
    v_pk_mul_f32 v[76:77], v[74:75], v[22:23] op_sel:[0,0] op_sel_hi:[0,1]
    v_pk_fma_f32 v[76:77], v[74:75], v[22:23], v[76:77] op_sel:[1,1,0] op_sel_hi:[1,0,1] neg_lo:[1,0,0]
    v_pk_mul_f32 v[44:45], v[42:43], v[20:21] op_sel:[0,0] op_sel_hi:[0,1]
    v_pk_fma_f32 v[44:45], v[42:43], v[20:21], v[44:45] op_sel:[1,1,0] op_sel_hi:[1,0,1] neg_lo:[1,0,0]
    v_cvt_pk_f16_f32 v9, v76, v77
    ds_write_addtid_b32 v9 offset:1728
    v_pk_mul_f32 v[78:79], v[76:77], v[22:23] op_sel:[0,0] op_sel_hi:[0,1]
    v_pk_fma_f32 v[78:79], v[76:77], v[22:23], v[78:79] op_sel:[1,1,0] op_sel_hi:[1,0,1] neg_lo:[1,0,0]
    v_pk_mul_f32 v[46:47], v[44:45], v[20:21] op_sel:[0,0] op_sel_hi:[0,1]
    v_pk_fma_f32 v[46:47], v[44:45], v[20:21], v[46:47] op_sel:[1,1,0] op_sel_hi:[1,0,1] neg_lo:[1,0,0]
    v_cvt_pk_f16_f32 v12, v78, v79
    ds_write_addtid_b32 v12 offset:2016
    v_pk_mul_f32 v[80:81], v[78:79], v[22:23] op_sel:[0,0] op_sel_hi:[0,1]
    v_pk_fma_f32 v[80:81], v[78:79], v[22:23], v[80:81] op_sel:[1,1,0] op_sel_hi:[1,0,1] neg_lo:[1,0,0]
    v_pk_mul_f32 v[48:49], v[46:47], v[20:21] op_sel:[0,0] op_sel_hi:[0,1]
    v_pk_fma_f32 v[48:49], v[46:47], v[20:21], v[48:49] op_sel:[1,1,0] op_sel_hi:[1,0,1] neg_lo:[1,0,0]
    v_cvt_pk_f16_f32 v14, v80, v81
    ds_write_addtid_b32 v14 offset:2304
    v_pk_mul_f32 v[82:83], v[80:81], v[22:23] op_sel:[0,0] op_sel_hi:[0,1]
    v_pk_fma_f32 v[82:83], v[80:81], v[22:23], v[82:83] op_sel:[1,1,0] op_sel_hi:[1,0,1] neg_lo:[1,0,0]
    v_pk_mul_f32 v[50:51], v[48:49], v[20:21] op_sel:[0,0] op_sel_hi:[0,1]
    v_pk_fma_f32 v[50:51], v[48:49], v[20:21], v[50:51] op_sel:[1,1,0] op_sel_hi:[1,0,1] neg_lo:[1,0,0]
    v_cvt_pk_f16_f32 v8, v82, v83
    ds_write_addtid_b32 v8 offset:2592
    v_pk_mul_f32 v[84:85], v[82:83], v[22:23] op_sel:[0,0] op_sel_hi:[0,1]
    v_pk_fma_f32 v[84:85], v[82:83], v[22:23], v[84:85] op_sel:[1,1,0] op_sel_hi:[1,0,1] neg_lo:[1,0,0]
    v_pk_mul_f32 v[52:53], v[50:51], v[20:21] op_sel:[0,0] op_sel_hi:[0,1]
    v_pk_fma_f32 v[52:53], v[50:51], v[20:21], v[52:53] op_sel:[1,1,0] op_sel_hi:[1,0,1] neg_lo:[1,0,0]
    v_cvt_pk_f16_f32 v9, v84, v85
    ds_write_addtid_b32 v9 offset:2880
    v_pk_mul_f32 v[86:87], v[84:85], v[22:23] op_sel:[0,0] op_sel_hi:[0,1]
    v_pk_fma_f32 v[86:87], v[84:85], v[22:23], v[86:87] op_sel:[1,1,0] op_sel_hi:[1,0,1] neg_lo:[1,0,0]
    v_pk_mul_f32 v[54:55], v[52:53], v[20:21] op_sel:[0,0] op_sel_hi:[0,1]
    v_pk_fma_f32 v[54:55], v[52:53], v[20:21], v[54:55] op_sel:[1,1,0] op_sel_hi:[1,0,1] neg_lo:[1,0,0]
    v_cvt_pk_f16_f32 v12, v86, v87
    ds_write_addtid_b32 v12 offset:3168
    v_pk_mul_f32 v[88:89], v[86:87], v[22:23] op_sel:[0,0] op_sel_hi:[0,1]
    v_pk_fma_f32 v[88:89], v[86:87], v[22:23], v[88:89] op_sel:[1,1,0] op_sel_hi:[1,0,1] neg_lo:[1,0,0]
    v_pk_mul_f32 v[56:57], v[54:55], v[20:21] op_sel:[0,0] op_sel_hi:[0,1]
    v_pk_fma_f32 v[56:57], v[54:55], v[20:21], v[56:57] op_sel:[1,1,0] op_sel_hi:[1,0,1] neg_lo:[1,0,0]
    v_cvt_pk_f16_f32 v14, v88, v89
    ds_write_addtid_b32 v14 offset:3456
    v_pk_mul_f32 v[90:91], v[88:89], v[22:23] op_sel:[0,0] op_sel_hi:[0,1]
    v_pk_fma_f32 v[90:91], v[88:89], v[22:23], v[90:91] op_sel:[1,1,0] op_sel_hi:[1,0,1] neg_lo:[1,0,0]
    v_pk_mul_f32 v[58:59], v[56:57], v[20:21] op_sel:[0,0] op_sel_hi:[0,1]
    v_pk_fma_f32 v[58:59], v[56:57], v[20:21], v[58:59] op_sel:[1,1,0] op_sel_hi:[1,0,1] neg_lo:[1,0,0]
    v_cvt_pk_f16_f32 v8, v90, v91
    ds_write_addtid_b32 v8 offset:3744
    v_pk_mul_f32 v[92:93], v[90:91], v[22:23] op_sel:[0,0] op_sel_hi:[0,1]
    v_pk_fma_f32 v[92:93], v[90:91], v[22:23], v[92:93] op_sel:[1,1,0] op_sel_hi:[1,0,1] neg_lo:[1,0,0]
    v_pk_mul_f32 v[60:61], v[58:59], v[20:21] op_sel:[0,0] op_sel_hi:[0,1]
    v_pk_fma_f32 v[60:61], v[58:59], v[20:21], v[60:61] op_sel:[1,1,0] op_sel_hi:[1,0,1] neg_lo:[1,0,0]
    v_cvt_pk_f16_f32 v9, v92, v93
    ds_write_addtid_b32 v9 offset:4032
    v_pk_mul_f32 v[94:95], v[92:93], v[22:23] op_sel:[0,0] op_sel_hi:[0,1]
    v_pk_fma_f32 v[94:95], v[92:93], v[22:23], v[94:95] op_sel:[1,1,0] op_sel_hi:[1,0,1] neg_lo:[1,0,0]
    v_pk_mul_f32 v[62:63], v[60:61], v[20:21] op_sel:[0,0] op_sel_hi:[0,1]
    v_pk_fma_f32 v[62:63], v[60:61], v[20:21], v[62:63] op_sel:[1,1,0] op_sel_hi:[1,0,1] neg_lo:[1,0,0]
    v_cvt_pk_f16_f32 v12, v94, v95
    ds_write_addtid_b32 v12 offset:4320
    ds_read_b128 v[112:115], v13 offset:0
    ds_read_b128 v[116:119], v13 offset:64
    ds_read_b128 v[120:123], v13 offset:128
    ds_read_b128 v[124:127], v13 offset:192
    v_pk_mul_f32 v[24:25], v[94:95], v[22:23] op_sel:[0,0] op_sel_hi:[0,1]
    v_pk_fma_f32 v[24:25], v[94:95], v[22:23], v[24:25] op_sel:[1,1,0] op_sel_hi:[1,0,1] neg_lo:[1,0,0]
    v_pk_mul_f32 v[26:27], v[24:25], v[24:25] op_sel:[0,0] op_sel_hi:[0,1]
    v_pk_fma_f32 v[26:27], v[24:25], v[24:25], v[26:27] op_sel:[1,1,0] op_sel_hi:[1,0,1] neg_lo:[1,0,0]
    v_cvt_pk_f16_f32 v64, v32, -v33
    v_pk_mul_f32 v[28:29], v[26:27], v[22:23] op_sel:[0,0] op_sel_hi:[0,1]
    ds_write_addtid_b32 v64 offset:0
    v_cvt_pk_f16_f32 v14, v34, -v35
    ds_write_addtid_b32 v14 offset:288
    v_cvt_pk_f16_f32 v65, v36, -v37
    v_pk_fma_f32 v[28:29], v[26:27], v[22:23], v[28:29] op_sel:[1,1,0] op_sel_hi:[1,0,1] neg_lo:[1,0,0]
    ds_write_addtid_b32 v65 offset:576
    v_cvt_pk_f16_f32 v8, v38, -v39
    ds_write_addtid_b32 v8 offset:864
    v_cvt_pk_f16_f32 v66, v40, -v41
    ds_write_addtid_b32 v66 offset:1152
    v_pk_mul_f32 v[80:81], v[26:27], v[26:27] op_sel:[0,0] op_sel_hi:[0,1]
    v_cvt_pk_f16_f32 v9, v42, -v43
    ds_write_addtid_b32 v9 offset:1440
    v_cvt_pk_f16_f32 v67, v44, -v45
    ds_write_addtid_b32 v67 offset:1728
    v_pk_fma_f32 v[80:81], v[26:27], v[26:27], v[80:81] op_sel:[1,1,0] op_sel_hi:[1,0,1] neg_lo:[1,0,0]
    v_cvt_pk_f16_f32 v12, v46, -v47
    ds_write_addtid_b32 v12 offset:2016
    v_cvt_pk_f16_f32 v68, v48, -v49
    ds_write_addtid_b32 v68 offset:2304
    v_cvt_pk_f16_f32 v14, v50, -v51
    v_cvt_pk_f16_f32 v72, v24, -v25
    ds_write_addtid_b32 v14 offset:2592
    v_cvt_pk_f16_f32 v69, v52, -v53
    ds_write_addtid_b32 v69 offset:2880
    v_cvt_pk_f16_f32 v8, v54, -v55
    v_cvt_pk_f16_f32 v73, v26, -v27
    ds_write_addtid_b32 v8 offset:3168
    v_cvt_pk_f16_f32 v70, v56, -v57
    ds_write_addtid_b32 v70 offset:3456
    v_cvt_pk_f16_f32 v9, v58, -v59
    ds_write_addtid_b32 v9 offset:3744
    v_cvt_pk_f16_f32 v74, v28, -v29
    v_cvt_pk_f16_f32 v71, v60, -v61
    ds_write_addtid_b32 v71 offset:4032
    v_cvt_pk_f16_f32 v12, v62, -v63
    ds_write_addtid_b32 v12 offset:4320
    v_cvt_pk_f16_f32 v75, v80, -v81
    ds_read_b128 v[96:99], v13 offset:0
    ds_read_b128 v[100:103], v13 offset:64
    ds_read_b128 v[104:107], v13 offset:128
    ds_read_b128 v[108:111], v13 offset:192
    v_pk_mul_f16 v32, v64, v72 op_sel:[0,0] op_sel_hi:[0,1]
    v_pk_fma_f16 v32, v64, v72, v32 op_sel:[1,1,0] op_sel_hi:[1,0,1] neg_lo:[1,0,0]
    ds_write_addtid_b32 v32 offset:0
    v_pk_mul_f16 v33, v65, v72 op_sel:[0,0] op_sel_hi:[0,1]
    v_pk_fma_f16 v33, v65, v72, v33 op_sel:[1,1,0] op_sel_hi:[1,0,1] neg_lo:[1,0,0]
    ds_write_addtid_b32 v33 offset:288
    v_pk_mul_f16 v34, v66, v72 op_sel:[0,0] op_sel_hi:[0,1]
    v_pk_fma_f16 v34, v66, v72, v34 op_sel:[1,1,0] op_sel_hi:[1,0,1] neg_lo:[1,0,0]
    ds_write_addtid_b32 v34 offset:576
    v_pk_mul_f16 v35, v67, v72 op_sel:[0,0] op_sel_hi:[0,1]
    v_pk_fma_f16 v35, v67, v72, v35 op_sel:[1,1,0] op_sel_hi:[1,0,1] neg_lo:[1,0,0]
    ds_write_addtid_b32 v35 offset:864
    v_pk_mul_f16 v36, v68, v72 op_sel:[0,0] op_sel_hi:[0,1]
    v_pk_fma_f16 v36, v68, v72, v36 op_sel:[1,1,0] op_sel_hi:[1,0,1] neg_lo:[1,0,0]
    ds_write_addtid_b32 v36 offset:1152
    v_pk_mul_f16 v37, v69, v72 op_sel:[0,0] op_sel_hi:[0,1]
    v_pk_fma_f16 v37, v69, v72, v37 op_sel:[1,1,0] op_sel_hi:[1,0,1] neg_lo:[1,0,0]
    ds_write_addtid_b32 v37 offset:1440
    v_pk_mul_f16 v38, v70, v72 op_sel:[0,0] op_sel_hi:[0,1]
    v_pk_fma_f16 v38, v70, v72, v38 op_sel:[1,1,0] op_sel_hi:[1,0,1] neg_lo:[1,0,0]
    ds_write_addtid_b32 v38 offset:1728
    v_pk_mul_f16 v39, v71, v72 op_sel:[0,0] op_sel_hi:[0,1]
    v_pk_fma_f16 v39, v71, v72, v39 op_sel:[1,1,0] op_sel_hi:[1,0,1] neg_lo:[1,0,0]
    ds_write_addtid_b32 v39 offset:2016
    v_pk_mul_f16 v40, v64, v73 op_sel:[0,0] op_sel_hi:[0,1]
    v_pk_fma_f16 v40, v64, v73, v40 op_sel:[1,1,0] op_sel_hi:[1,0,1] neg_lo:[1,0,0]
    ds_write_addtid_b32 v40 offset:2304
    v_pk_mul_f16 v41, v66, v73 op_sel:[0,0] op_sel_hi:[0,1]
    v_pk_fma_f16 v41, v66, v73, v41 op_sel:[1,1,0] op_sel_hi:[1,0,1] neg_lo:[1,0,0]
    ds_write_addtid_b32 v41 offset:2592
    ds_read_b128 v[80:83], v13 offset:0
    ds_read_b128 v[84:87], v13 offset:64
    ds_read_b128 v[88:91], v13 offset:128
    ds_read_b128 v[92:95], v13 offset:192
    v_pk_mul_f16 v44, v68, v73 op_sel:[0,0] op_sel_hi:[0,1]
    v_pk_fma_f16 v44, v68, v73, v44 op_sel:[1,1,0] op_sel_hi:[1,0,1] neg_lo:[1,0,0]
    ds_write_addtid_b32 v44 offset:0
    v_pk_mul_f16 v45, v70, v73 op_sel:[0,0] op_sel_hi:[0,1]
    v_pk_fma_f16 v45, v70, v73, v45 op_sel:[1,1,0] op_sel_hi:[1,0,1] neg_lo:[1,0,0]
    ds_write_addtid_b32 v45 offset:288
    v_pk_mul_f16 v46, v64, v74 op_sel:[0,0] op_sel_hi:[0,1]
    v_pk_fma_f16 v46, v64, v74, v46 op_sel:[1,1,0] op_sel_hi:[1,0,1] neg_lo:[1,0,0]
    ds_write_addtid_b32 v46 offset:576
    v_pk_mul_f16 v47, v66, v74 op_sel:[0,0] op_sel_hi:[0,1]
    v_pk_fma_f16 v47, v66, v74, v47 op_sel:[1,1,0] op_sel_hi:[1,0,1] neg_lo:[1,0,0]
    ds_write_addtid_b32 v47 offset:864
    v_pk_mul_f16 v48, v44, v72 op_sel:[0,0] op_sel_hi:[0,1]
    v_pk_fma_f16 v48, v44, v72, v48 op_sel:[1,1,0] op_sel_hi:[1,0,1] neg_lo:[1,0,0]
    ds_write_addtid_b32 v48 offset:1152
    v_pk_mul_f16 v49, v45, v72 op_sel:[0,0] op_sel_hi:[0,1]
    v_pk_fma_f16 v49, v45, v72, v49 op_sel:[1,1,0] op_sel_hi:[1,0,1] neg_lo:[1,0,0]
    ds_write_addtid_b32 v49 offset:1440
    v_pk_mul_f16 v50, v46, v72 op_sel:[0,0] op_sel_hi:[0,1]
    v_pk_fma_f16 v50, v46, v72, v50 op_sel:[1,1,0] op_sel_hi:[1,0,1] neg_lo:[1,0,0]
    ds_write_addtid_b32 v50 offset:1728
    v_pk_mul_f16 v51, v47, v72 op_sel:[0,0] op_sel_hi:[0,1]
    v_pk_fma_f16 v51, v47, v72, v51 op_sel:[1,1,0] op_sel_hi:[1,0,1] neg_lo:[1,0,0]
    ds_write_addtid_b32 v51 offset:2016
    v_lshl_add_u32 v2, v1, 4, s12
    s_cmp_eq_u32 s7, 0
    s_cbranch_scc1 L_acc0
    v_subrev_u32 v15, 18304, v2
    s_nop 1
L_accspin:
    ds_read_b32 v4, v3
    s_waitcnt lgkmcnt(0)
    v_readfirstlane_b32 s15, v4
    s_cmp_lt_u32 s15, s7
    s_nop 2
    s_cbranch_scc1 L_accspin
    ds_read_b128 v[4:7], v15
    ds_read_b128 v[16:19], v15 offset:1024
    ds_read_b128 v[28:31], v15 offset:2048
L_accdone:
    v_pk_mul_f16 v52, v44, v73 op_sel:[0,0] op_sel_hi:[0,1]
    v_pk_fma_f16 v52, v44, v73, v52 op_sel:[1,1,0] op_sel_hi:[1,0,1] neg_lo:[1,0,0]
    ds_write_addtid_b32 v52 offset:2304
    v_pk_mul_f16 v53, v46, v73 op_sel:[0,0] op_sel_hi:[0,1]
    v_pk_fma_f16 v53, v46, v73, v53 op_sel:[1,1,0] op_sel_hi:[1,0,1] neg_lo:[1,0,0]
    ds_write_addtid_b32 v53 offset:2592
    v_pk_mul_f16 v54, v48, v73 op_sel:[0,0] op_sel_hi:[0,1]
    v_pk_fma_f16 v54, v48, v73, v54 op_sel:[1,1,0] op_sel_hi:[1,0,1] neg_lo:[1,0,0]
    ds_write_addtid_b32 v54 offset:2880
    v_pk_mul_f16 v55, v50, v73 op_sel:[0,0] op_sel_hi:[0,1]
    v_pk_fma_f16 v55, v50, v73, v55 op_sel:[1,1,0] op_sel_hi:[1,0,1] neg_lo:[1,0,0]
    ds_write_addtid_b32 v55 offset:3168
    s_waitcnt lgkmcnt(4)
    v_mfma_f32_16x16x32_f16 v[4:7], v[96:99], v[112:115], v[4:7]
    v_mfma_f32_16x16x32_f16 v[4:7], v[100:103], v[116:119], v[4:7]
    v_mfma_f32_16x16x32_f16 v[4:7], v[104:107], v[120:123], v[4:7]
    v_mfma_f32_16x16x32_f16 v[4:7], v[108:111], v[124:127], v[4:7]
    v_pk_mul_f16 v56, v44, v75 op_sel:[0,0] op_sel_hi:[0,1]
    v_pk_fma_f16 v56, v44, v75, v56 op_sel:[1,1,0] op_sel_hi:[1,0,1] neg_lo:[1,0,0]
    ds_write_addtid_b32 v56 offset:3456
    v_pk_mul_f16 v57, v46, v75 op_sel:[0,0] op_sel_hi:[0,1]
    v_pk_fma_f16 v57, v46, v75, v57 op_sel:[1,1,0] op_sel_hi:[1,0,1] neg_lo:[1,0,0]
    ds_write_addtid_b32 v57 offset:3744
    v_pk_mul_f16 v58, v48, v75 op_sel:[0,0] op_sel_hi:[0,1]
    v_pk_fma_f16 v58, v48, v75, v58 op_sel:[1,1,0] op_sel_hi:[1,0,1] neg_lo:[1,0,0]
    ds_write_addtid_b32 v58 offset:4032
    v_pk_mul_f16 v59, v50, v75 op_sel:[0,0] op_sel_hi:[0,1]
    v_pk_fma_f16 v59, v50, v75, v59 op_sel:[1,1,0] op_sel_hi:[1,0,1] neg_lo:[1,0,0]
    ds_write_addtid_b32 v59 offset:4320
    ds_read_b128 v[96:99], v13 offset:0
    ds_read_b128 v[100:103], v13 offset:64
    ds_read_b128 v[104:107], v13 offset:128
    ds_read_b128 v[108:111], v13 offset:192
    v_mfma_f32_16x16x32_f16 v[16:19], v[80:83], v[112:115], v[16:19]
    v_mfma_f32_16x16x32_f16 v[16:19], v[84:87], v[116:119], v[16:19]
    v_mfma_f32_16x16x32_f16 v[16:19], v[88:91], v[120:123], v[16:19]
    v_mfma_f32_16x16x32_f16 v[16:19], v[92:95], v[124:127], v[16:19]
    v_mov_b32 v8, 1
    s_waitcnt lgkmcnt(0)
    v_mfma_f32_16x16x32_f16 v[28:31], v[112:115], v[96:99], v[28:31]
    v_mfma_f32_16x16x32_f16 v[28:31], v[116:119], v[100:103], v[28:31]
    v_mfma_f32_16x16x32_f16 v[28:31], v[120:123], v[104:107], v[28:31]
    v_mfma_f32_16x16x32_f16 v[28:31], v[124:127], v[108:111], v[28:31]
    s_cmp_eq_u32 s7, 2
    s_nop 5
    s_cbranch_scc1 L_finAB
    ds_write_b128 v2, v[4:7]
    ds_write_b128 v2, v[16:19] offset:1024
    ds_write_b128 v2, v[28:31] offset:2048
    s_mov_b32 exec_lo, 1
    s_mov_b32 exec_hi, 0
    ds_add_u32 v3, v8
    s_mov_b64 exec, -1
    s_cmp_eq_u32 s7, 0
    s_cbranch_scc1 L_B0
    v_and_b32 v8, 15, v1
    v_lshrrev_b32 v9, 4, v1
    s_nop 0
    s_branch L_finC
L_finAB:
    v_cvt_pk_f16_f32 v70, v7, v6
    v_cvt_pk_f16_f32 v71, v5, v4
    v_cvt_pk_f16_f32 v72, v6, v5
    ds_write_b128 v2, v[28:31] offset:2048
    s_mov_b32 exec_lo, 1
    s_mov_b32 exec_hi, 0
    ds_add_u32 v3, v8
    s_mov_b32 exec_lo, 0
    s_mov_b32 exec_hi, 1
    v_mov_b32 v18, v17
    v_mov_b32 v17, v16
    v_mov_b32 v19, 0
    s_mov_b64 exec, -1
    v_cvt_pk_f16_f32 v60, v19, v18
    v_cvt_pk_f16_f32 v61, v18, v18
    v_cvt_pk_f16_f32 v62, v17, v16
    v_cvt_pk_f16_f32 v63, v16, v16
    v_cvt_pk_f16_f32 v65, v18, v17
    s_mov_b32 exec_hi, 1
    ds_write_b128 v11, v[60:63] offset:2494
    ds_write_b16 v11, v60
    ds_write_b32 v11, v61 offset:2
    ds_write_b32 v11, v65 offset:6
    ds_write_b32 v11, v63 offset:10
    ds_write_b16 v11, v63 offset:14
    s_mov_b64 exec, -1
    ds_write_b64 v10, v[70:71]
    ds_write_b16 v10, v70 offset:2494
    ds_write_b32 v10, v72 offset:2496
    ds_write_b16_d16_hi v10, v71 offset:2500
    s_branch L_B0
L_finC:
    v_and_b32 v13, 3, v8
    v_lshrrev_b32 v14, 2, v8
    v_and_b32 v15, 1, v8
    v_add_u32 v15, 4, v15
    v_subrev_u32 v16, 8, v8
    v_lshrrev_b32 v16, 1, v16
    v_cmp_lt_u32 vcc, 7, v8
    s_nop 1
    v_cndmask_b32 v13, v13, v15, vcc
    v_cndmask_b32 v14, v14, v16, vcc
    v_mul_u32_u24 v13, 208, v13
    v_lshlrev_b32_e64 v14, 5, v14
    v_lshl_add_u32 v14, v9, 3, v14
    v_sub_u32_e64 v13, v13, v14
    v_add_u32 v13, 1352, v13
    v_add_u32 v13, s46, v13
    v_mov_b32 v14, s46
    s_lshl_b32 s47, s6, 4
    s_add_u32 s47, s47, 158272
    v_mov_b32 v15, s47
    v_mov_b32 v75, s40
    s_nop 1
L_fspinC:
    ds_read_b32 v16, v3
    s_waitcnt lgkmcnt(0)
    v_readfirstlane_b32 s15, v16
    s_cmp_lt_u32 s15, 3
    s_nop 2
    s_cbranch_scc1 L_fspinC
    ds_read_b128 v[32:35], v2 offset:20352
    s_waitcnt lgkmcnt(0)
    v_cvt_pk_f16_f32 v70, v35, v34
    v_cvt_pk_f16_f32 v71, v33, v32
    v_cvt_pk_f16_f32 v72, v34, v33
    v_cvt_pk_f16_f32 v74, -v35, 0
    ds_write_b64 v13, v[70:71]
    ds_write_b16 v13, v70 offset:2494
    ds_write_b32 v13, v72 offset:2496
    ds_write_b16_d16_hi v13, v71 offset:2500
    s_mov_b32 exec_lo, 0
    s_mov_b32 exec_hi, 0x400000
    ds_write_b16 v14, v70 offset:1920
    ds_write_b16 v14, v70 offset:4414
    ds_write_b64 v15, v[74:75]
    s_mov_b64 exec, -1
    s_branch L_B0
L_uwave:
    s_mul_i32 s15, s6, 15840
    s_add_u32 s15, s15, 94848
    v_lshl_add_u32 v3, v1, 4, s15
    ds_write_b128 v3, v[4:7]
    ds_write_b128 v3, v[4:7] offset:416
    s_mov_b32 exec_hi, 0
    s_mov_b32 exec_lo, 3
    ds_write_b128 v3, v[4:7] offset:7584
    ds_write_b128 v3, v[4:7] offset:10688
    s_mov_b64 exec, -1
    s_mov_b32 s13, 0x7fff7fff
    s_mov_b32 s14, 0x80008000
    v_mov_b32 v13, 1
    v_and_b32 v2, 15, v1
    v_lshrrev_b32 v3, 4, v1
    v_lshlrev_b32 v3, 3, v3
    s_movk_i32 s15, 0x3c00
    v_lshrrev_b32 v5, 1, v3
    buffer_load_dwordx2 v[24:25], v9, s[36:39], s12 offen offset:0
    v_mov_b32 v4, 1984
    v_lshlrev_b32 v4, v2, v4
    v_lshrrev_b32 v4, v5, v4
    v_bfe_u32 v96, v4, 0, 2
    v_lshl_or_b32 v96, v96, 15, v96
    v_and_b32 v96, 0x10001, v96
    v_mul_u32_u24_e64 v96, s15, v96
    v_bfe_u32 v97, v4, 2, 2
    v_lshl_or_b32 v97, v97, 15, v97
    v_and_b32 v97, 0x10001, v97
    v_mul_u32_u24_e64 v97, s15, v97
    v_bfe_u32 v98, v4, 16, 2
    v_lshl_or_b32 v98, v98, 15, v98
    v_and_b32 v98, 0x10001, v98
    v_mul_u32_u24_e64 v98, s15, v98
    v_bfe_u32 v99, v4, 18, 2
    v_lshl_or_b32 v99, v99, 15, v99
    v_and_b32 v99, 0x10001, v99
    v_mul_u32_u24_e64 v99, s15, v99
    buffer_load_dwordx2 v[26:27], v9, s[36:39], s12 offen offset:1280
    v_mov_b32 v4, 56
    v_lshlrev_b32 v4, v2, v4
    v_lshrrev_b32_e64 v4, v5, v4
    v_bfe_u32 v100, v4, 0, 2
    v_lshl_or_b32 v100, v100, 15, v100
    v_and_b32 v100, 0x10001, v100
    v_mul_u32_u24_e64 v100, s15, v100
    v_bfe_u32 v101, v4, 2, 2
    v_lshl_or_b32 v101, v101, 15, v101
    v_and_b32 v101, 0x10001, v101
    v_mul_u32_u24_e64 v101, s15, v101
    v_bfe_u32 v102, v4, 16, 2
    v_lshl_or_b32 v102, v102, 15, v102
    v_and_b32 v102, 0x10001, v102
    v_mul_u32_u24_e64 v102, s15, v102
    v_bfe_u32 v103, v4, 18, 2
    v_lshl_or_b32 v103, v103, 15, v103
    v_and_b32 v103, 0x10001, v103
    v_mul_u32_u24_e64 v103, s15, v103
    buffer_load_dwordx2 v[28:29], v9, s[36:39], s12 offen offset:2560
    v_mov_b32 v4, 4064
    v_lshlrev_b32 v4, v2, v4
    v_lshrrev_b32 v4, v5, v4
    v_bfe_u32 v104, v4, 0, 2
    v_lshl_or_b32 v104, v104, 15, v104
    v_and_b32 v104, 0x10001, v104
    v_mul_u32_u24_e64 v104, s15, v104
    v_bfe_u32 v105, v4, 2, 2
    v_lshl_or_b32 v105, v105, 15, v105
    v_and_b32 v105, 0x10001, v105
    v_mul_u32_u24_e64 v105, s15, v105
    v_bfe_u32 v106, v4, 16, 2
    v_lshl_or_b32 v106, v106, 15, v106
    v_and_b32 v106, 0x10001, v106
    v_mul_u32_u24_e64 v106, s15, v106
    v_bfe_u32 v107, v4, 18, 2
    v_lshl_or_b32 v107, v107, 15, v107
    v_and_b32 v107, 0x10001, v107
    v_mul_u32_u24_e64 v107, s15, v107
    buffer_load_dwordx2 v[30:31], v9, s[36:39], s12 offen offset:3840
    v_mov_b32 v4, 2093056
    v_lshlrev_b32 v4, v2, v4
    v_lshrrev_b32 v4, v5, v4
    v_bfe_u32 v108, v4, 0, 2
    v_lshl_or_b32 v108, v108, 15, v108
    v_and_b32 v108, 0x10001, v108
    v_mul_u32_u24_e64 v108, s15, v108
    v_bfe_u32 v109, v4, 2, 2
    v_lshl_or_b32 v109, v109, 15, v109
    v_and_b32 v109, 0x10001, v109
    v_mul_u32_u24_e64 v109, s15, v109
    v_bfe_u32 v110, v4, 16, 2
    v_lshl_or_b32 v110, v110, 15, v110
    v_and_b32 v110, 0x10001, v110
    v_mul_u32_u24_e64 v110, s15, v110
    v_bfe_u32 v111, v4, 18, 2
    v_lshl_or_b32 v111, v111, 15, v111
    v_and_b32 v111, 0x10001, v111
    v_mul_u32_u24_e64 v111, s15, v111
    global_load_dwordx2 v[32:33], v10, s[28:29]
    v_mov_b32 v4, 511
    v_lshlrev_b32 v4, v2, v4
    v_lshrrev_b32 v4, 20, v4
    v_lshlrev_b32 v4, 16, v4
    v_lshrrev_b32 v4, v5, v4
    v_bfe_u32 v92, v4, 0, 2
    v_lshl_or_b32 v92, v92, 15, v92
    v_and_b32 v92, 0x10001, v92
    v_mul_u32_u24_e64 v92, s15, v92
    v_bfe_u32 v93, v4, 2, 2
    v_lshl_or_b32 v93, v93, 15, v93
    v_and_b32 v93, 0x10001, v93
    v_mul_u32_u24_e64 v93, s15, v93
    v_bfe_u32 v94, v4, 16, 2
    v_lshl_or_b32 v94, v94, 15, v94
    v_and_b32 v94, 0x10001, v94
    v_mul_u32_u24_e64 v94, s15, v94
    v_bfe_u32 v95, v4, 18, 2
    v_lshl_or_b32 v95, v95, 15, v95
    v_and_b32 v95, 0x10001, v95
    v_mul_u32_u24_e64 v95, s15, v95
    s_mul_i32 s15, s6, 15840
    s_add_u32 s15, s15, 94848
    v_lshrrev_b32 v120, 2, v2
    v_lshlrev_b32 v120, 3, v120
    v_xor_b32_e64 v120, v3, v120
    v_lshl_add_u32 v120, v2, 5, v120
    v_lshl_add_u32 v119, s6, 11, v120
    v_add_u32 v119, 46080, v119
    v_add_u32 v120, s15, v120
    v_lshrrev_b32 v121, 1, v2
    v_mul_u32_u24 v121, 96, v121
    v_lshl_add_u32 v121, v3, 1, v121
    v_add_u32 v121, s15, v121
    v_and_b32 v4, 1, v2
    v_mul_u32_u24 v5, 80, v4
    v_add3_u32 v122, v121, v5, 8
    v_lshl_add_u32 v122, v4, 3, v122
    v_lshl_add_u32 v121, v4, 3, v121
    v_lshrrev_b32_e64 v4, 4, v8
    v_mul_u32_u24 v6, 96, v4
    v_mul_u32_u24 v4, 144, v4
    v_and_b32_e64 v5, 15, v8
    v_lshl_add_u32 v123, v5, 3, v4
    v_bfe_u32 v124, v5, 1, 2
    v_lshl_add_u32 v6, v124, 4, v6
    v_bfe_u32 v124, v5, 3, 1
    v_lshl_add_u32 v6, v124, 3, v6
    v_and_b32_e64 v124, 1, v5
    v_lshl_add_u32 v124, v124, 2, v6
    v_add_u32 v124, 96288, v124
    v_add_u32 v125, 54912, v123
    v_mul_u32_u24 v126, 2560, v8
    v_add_u32 v126, s10, v126
    v_lshrrev_b32 v14, 2, v8
    v_mul_u32_u24 v14, 96, v14
    v_and_b32_e64 v15, 3, v8
    v_lshl_add_u32 v11, v15, 4, v14
    v_add_u32 v11, 96288, v11
    s_waitcnt vmcnt(8)
    v_and_b32 v36, s13, v16
    v_and_b32 v37, s13, v17
    s_waitcnt vmcnt(7)
    v_and_b32 v38, s13, v18
    v_and_b32 v39, s13, v19
    v_pk_max_u16 v52, v36, v38
    v_pk_max_u16 v53, v37, v39
    s_waitcnt vmcnt(6)
    v_and_b32 v40, s13, v20
    v_and_b32_e64 v41, s13, v21
    v_pk_max_u16 v52, v52, v40
    v_pk_max_u16 v53, v53, v41
    s_waitcnt vmcnt(5)
    v_and_b32 v42, s13, v22
    v_and_b32_e64 v43, s13, v23
    v_pk_max_u16 v52, v52, v42
    v_pk_max_u16 v53, v53, v43
    s_waitcnt vmcnt(4)
    v_and_b32 v44, s13, v24
    v_and_b32_e64 v45, s13, v25
    v_pk_max_u16 v52, v52, v44
    v_pk_max_u16 v53, v53, v45
    s_waitcnt vmcnt(3)
    v_and_b32 v46, s13, v26
    v_and_b32_e64 v47, s13, v27
    v_pk_max_u16 v52, v52, v46
    v_pk_max_u16 v53, v53, v47
    s_waitcnt vmcnt(2)
    v_and_b32 v48, s13, v28
    v_and_b32_e64 v49, s13, v29
    v_pk_max_u16 v52, v52, v48
    v_pk_max_u16 v53, v53, v49
    s_waitcnt vmcnt(1)
    v_and_b32 v50, s13, v30
    v_and_b32_e64 v51, s13, v31
    v_pk_max_u16 v52, v52, v50
    v_pk_max_u16 v53, v53, v51
    s_nop 0
    v_mov_b32_dpp v56, v52 row_shr:1 row_mask:0xf bank_mask:0xf bound_ctrl:0
    v_mov_b32_dpp v57, v53 row_shr:1 row_mask:0xf bank_mask:0xf bound_ctrl:0
    v_pk_max_u16 v52, v52, v56
    v_pk_max_u16 v53, v53, v57
    s_nop 0
    v_mov_b32_dpp v56, v52 row_shr:2 row_mask:0xf bank_mask:0xf bound_ctrl:0
    v_mov_b32_dpp v57, v53 row_shr:2 row_mask:0xf bank_mask:0xf bound_ctrl:0
    v_pk_max_u16 v52, v52, v56
    v_pk_max_u16 v53, v53, v57
    s_nop 0
    v_mov_b32_dpp v56, v52 row_shr:4 row_mask:0xf bank_mask:0xf bound_ctrl:0
    v_mov_b32_dpp v57, v53 row_shr:4 row_mask:0xf bank_mask:0xf bound_ctrl:0
    v_pk_max_u16 v52, v52, v56
    v_pk_max_u16 v53, v53, v57
    s_nop 0
    v_mov_b32_dpp v56, v52 row_shr:8 row_mask:0xf bank_mask:0xf bound_ctrl:0
    v_mov_b32_dpp v57, v53 row_shr:8 row_mask:0xf bank_mask:0xf bound_ctrl:0
    v_pk_max_u16 v52, v52, v56
    v_pk_max_u16 v53, v53, v57
    s_mov_b32 exec_lo, 0x80008000
    s_mov_b32 exec_hi, 0x80008000
    v_lshlrev_b32 v54, 16, v52
    v_lshlrev_b32 v55, 16, v53
    ds_max_u32 v12, v54 offset:32
    ds_max_u32 v12, v52 offset:36
    ds_max_u32 v12, v55 offset:40
    ds_max_u32 v12, v53 offset:44
    s_mov_b32 exec_lo, 1
    s_mov_b32 exec_hi, 0
    ds_add_u32 v12, v13 offset:16
    s_mov_b64 exec, -1
    s_mov_b32 s47, 0x05040100
    s_mov_b32 s48, 0x07060302
L_spin1:
    ds_read_b32 v14, v12 offset:16
    s_waitcnt lgkmcnt(0)
    v_readfirstlane_b32 s59, v14
    s_cmp_lt_u32 s59, 4
    s_nop 2
    s_cbranch_scc1 L_spin1
    ds_read_b128 v[56:59], v12 offset:32
    s_mov_b32 s15, 0x7f807f80
    s_mov_b32 s46, 0xd000d00
    s_waitcnt lgkmcnt(0)
    v_perm_b32 v52, v57, v56, s48
    v_perm_b32 v53, v59, v58, s48
    v_and_b32 v52, s15, v52
    v_and_b32_e64 v53, s15, v53
    v_pk_max_u16 v52, v52, s46
    v_pk_max_u16 v53, v53, s46
    v_pk_sub_u16 v54, v52, s46
    v_pk_sub_u16 v55, v53, s46
    v_pk_sub_u16 v36, v36, v54 clamp
    v_pk_lshlrev_b16 v36, 3, v36 op_sel_hi:[0,1]
    v_and_or_b32 v36, v16, s14, v36
    v_pk_sub_u16 v37, v37, v55 clamp
    v_pk_lshlrev_b16 v37, 3, v37 op_sel_hi:[0,1]
    v_and_or_b32 v37, v17, s14, v37
    v_pk_sub_u16 v38, v38, v54 clamp
    v_pk_lshlrev_b16 v38, 3, v38 op_sel_hi:[0,1]
    v_and_or_b32 v38, v18, s14, v38
    v_pk_sub_u16 v39, v39, v55 clamp
    v_pk_lshlrev_b16 v39, 3, v39 op_sel_hi:[0,1]
    v_and_or_b32 v39, v19, s14, v39
    v_pk_sub_u16 v40, v40, v54 clamp
    v_pk_lshlrev_b16 v40, 3, v40 op_sel_hi:[0,1]
    v_and_or_b32 v40, v20, s14, v40
    v_pk_sub_u16 v41, v41, v55 clamp
    v_pk_lshlrev_b16 v41, 3, v41 op_sel_hi:[0,1]
    v_and_or_b32 v41, v21, s14, v41
    v_pk_sub_u16 v42, v42, v54 clamp
    v_pk_lshlrev_b16 v42, 3, v42 op_sel_hi:[0,1]
    v_and_or_b32 v42, v22, s14, v42
    v_pk_sub_u16 v43, v43, v55 clamp
    v_pk_lshlrev_b16 v43, 3, v43 op_sel_hi:[0,1]
    v_and_or_b32 v43, v23, s14, v43
    v_pk_sub_u16 v44, v44, v54 clamp
    v_pk_lshlrev_b16 v44, 3, v44 op_sel_hi:[0,1]
    v_and_or_b32 v44, v24, s14, v44
    v_pk_sub_u16 v45, v45, v55 clamp
    v_pk_lshlrev_b16 v45, 3, v45 op_sel_hi:[0,1]
    v_and_or_b32 v45, v25, s14, v45
    v_pk_sub_u16 v46, v46, v54 clamp
    v_pk_lshlrev_b16 v46, 3, v46 op_sel_hi:[0,1]
    v_and_or_b32 v46, v26, s14, v46
    v_pk_sub_u16 v47, v47, v55 clamp
    v_pk_lshlrev_b16 v47, 3, v47 op_sel_hi:[0,1]
    v_and_or_b32 v47, v27, s14, v47
    v_pk_sub_u16 v48, v48, v54 clamp
    v_pk_lshlrev_b16 v48, 3, v48 op_sel_hi:[0,1]
    v_and_or_b32 v48, v28, s14, v48
    v_pk_sub_u16 v49, v49, v55 clamp
    v_pk_lshlrev_b16 v49, 3, v49 op_sel_hi:[0,1]
    v_and_or_b32 v49, v29, s14, v49
    v_pk_sub_u16 v50, v50, v54 clamp
    v_pk_lshlrev_b16 v50, 3, v50 op_sel_hi:[0,1]
    v_and_or_b32 v50, v30, s14, v50
    v_pk_sub_u16 v51, v51, v55 clamp
    v_pk_lshlrev_b16 v51, 3, v51 op_sel_hi:[0,1]
    v_and_or_b32 v51, v31, s14, v51
    v_perm_b32 v60, v38, v36, s47
    v_perm_b32 v61, v42, v40, s47
    v_perm_b32 v62, v46, v44, s47
    v_perm_b32 v63, v50, v48, s47
    ds_write_b128 v11, v[60:63] offset:0
    v_perm_b32 v64, v38, v36, s48
    v_perm_b32 v65, v42, v40, s48
    v_perm_b32 v66, v46, v44, s48
    v_perm_b32 v67, v50, v48, s48
    ds_write_b128 v11, v[64:67] offset:15840
    v_perm_b32 v68, v39, v37, s47
    v_perm_b32 v69, v43, v41, s47
    v_perm_b32 v70, v47, v45, s47
    v_perm_b32 v71, v51, v49, s47
    ds_write_b128 v11, v[68:71] offset:31680
    v_perm_b32 v72, v39, v37, s48
    v_perm_b32 v73, v43, v41, s48
    v_perm_b32 v74, v47, v45, s48
    v_perm_b32 v75, v51, v49, s48
    ds_write_b128 v11, v[72:75] offset:47520
    v_readfirstlane_b32 s50, v52
    v_readfirstlane_b32 s52, v53
    s_waitcnt vmcnt(0)
    v_lshlrev_b32 v76, 16, v32
    v_and_b32 v77, 0xffff0000, v32
    v_lshlrev_b32_e64 v78, 16, v33
    v_and_b32 v79, 0xffff0000, v33
    s_lshr_b32 s51, s50, 23
    s_bfe_u32 s50, s50, 0x80007
    s_lshr_b32 s53, s52, 23
    s_bfe_u32 s52, s52, 0x80007
    s_waitcnt lgkmcnt(0)
    s_barrier
    s_setprio 3
    ds_read_b32 v112, v12 offset:68
    ds_read_b32 v113, v12 offset:84
    ds_read_b32 v114, v12 offset:100
    ds_read_b32 v115, v12 offset:116
    ds_read_b64 v[16:17], v121 offset:1344
    ds_read_b64 v[18:19], v122 offset:1344
    ds_read_b64 v[20:21], v121 offset:1440
    ds_read_b64 v[22:23], v121 offset:2112
    ds_read_b64 v[24:25], v122 offset:2112
    ds_read_b64 v[26:27], v121 offset:2208
    ds_read_b64 v[28:29], v121 offset:2880
    ds_read_b64 v[30:31], v122 offset:2880
    ds_read_b64 v[32:33], v121 offset:2976
    ds_read_b64 v[34:35], v121 offset:3648
    ds_read_b64 v[36:37], v122 offset:3648
    ds_read_b64 v[38:39], v121 offset:3744
    s_waitcnt lgkmcnt(6)
    ds_read_b64 v[42:43], v122 offset:4416
    ds_read_b64 v[44:45], v121 offset:4512
    ds_read_b64 v[48:49], v122 offset:5184
    ds_read_b64 v[50:51], v121 offset:5280
    s_waitcnt lgkmcnt(0)
    v_mfma_f32_16x16x32_f16 v[56:59], v[96:99], v[18:21], 0
    v_mfma_f32_16x16x32_f16 v[60:63], v[100:103], v[18:21], 0
    v_mfma_f32_16x16x32_f16 v[64:67], v[104:107], v[18:21], 0
    v_mfma_f32_16x16x32_f16 v[68:71], v[108:111], v[16:19], 0
    v_mfma_f32_16x16x32_f16 v[68:71], v[92:95], v[18:21], v[68:71]
    s_nop 3
    v_cvt_pk_f16_f32 v56, v56, v57
    v_cvt_pk_f16_f32 v57, v58, v59
    ds_write_b64 v120, v[56:57] offset:7616
    v_mfma_f32_16x16x32_f16 v[72:75], v[96:99], v[24:27], 0
    v_cvt_pk_f16_f32 v60, v60, v61
    v_cvt_pk_f16_f32 v61, v62, v63
    ds_write_b64 v120, v[60:61] offset:10720
    v_mfma_f32_16x16x32_f16 v[56:59], v[100:103], v[24:27], 0
    v_cvt_pk_f16_f32 v64, v64, v65
    v_cvt_pk_f16_f32 v65, v66, v67
    ds_write_b64 v120, v[64:65] offset:13792
    v_mfma_f32_16x16x32_f16 v[60:63], v[104:107], v[24:27], 0
    v_cvt_pk_f16_f32 v68, v68, v69
    v_cvt_pk_f16_f32 v69, v70, v71
    ds_write_b64 v119, v[68:69] offset:0
    v_mfma_f32_16x16x32_f16 v[64:67], v[108:111], v[22:25], 0
    v_mfma_f32_16x16x32_f16 v[64:67], v[92:95], v[24:27], v[64:67]
    v_cvt_pk_f16_f32 v72, v72, v73
    v_cvt_pk_f16_f32 v73, v74, v75
    ds_write_b64 v120, v[72:73] offset:8128
    v_mfma_f32_16x16x32_f16 v[68:71], v[96:99], v[30:33], 0
    v_cvt_pk_f16_f32 v56, v56, v57
    v_cvt_pk_f16_f32 v57, v58, v59
    ds_write_b64 v120, v[56:57] offset:11232
    v_mfma_f32_16x16x32_f16 v[72:75], v[100:103], v[30:33], 0
    v_cvt_pk_f16_f32 v60, v60, v61
    v_cvt_pk_f16_f32 v61, v62, v63
    ds_write_b64 v120, v[60:61] offset:14304
    v_mfma_f32_16x16x32_f16 v[56:59], v[104:107], v[30:33], 0
    v_cvt_pk_f16_f32 v64, v64, v65
    v_cvt_pk_f16_f32 v65, v66, v67
    ds_write_b64 v119, v[64:65] offset:512
    v_mfma_f32_16x16x32_f16 v[60:63], v[108:111], v[28:31], 0
    v_mfma_f32_16x16x32_f16 v[60:63], v[92:95], v[30:33], v[60:63]
    v_cvt_pk_f16_f32 v68, v68, v69
    v_cvt_pk_f16_f32 v69, v70, v71
    ds_write_b64 v120, v[68:69] offset:8640
    v_mfma_f32_16x16x32_f16 v[64:67], v[96:99], v[36:39], 0
    v_cvt_pk_f16_f32 v72, v72, v73
    v_cvt_pk_f16_f32 v73, v74, v75
    ds_write_b64 v120, v[72:73] offset:11744
    v_mfma_f32_16x16x32_f16 v[68:71], v[100:103], v[36:39], 0
    v_cvt_pk_f16_f32 v56, v56, v57
    v_cvt_pk_f16_f32 v57, v58, v59
    ds_write_b64 v120, v[56:57] offset:14816
    v_mfma_f32_16x16x32_f16 v[72:75], v[104:107], v[36:39], 0
    v_cvt_pk_f16_f32 v60, v60, v61
    v_cvt_pk_f16_f32 v61, v62, v63
    ds_write_b64 v119, v[60:61] offset:1024
    v_mfma_f32_16x16x32_f16 v[56:59], v[108:111], v[34:37], 0
    v_mfma_f32_16x16x32_f16 v[56:59], v[92:95], v[36:39], v[56:59]
    v_cvt_pk_f16_f32 v64, v64, v65
    v_cvt_pk_f16_f32 v65, v66, v67
    ds_write_b64 v120, v[64:65] offset:9152
    v_mfma_f32_16x16x32_f16 v[60:63], v[96:99], v[42:45], 0
    v_cvt_pk_f16_f32 v68, v68, v69
    v_cvt_pk_f16_f32 v69, v70, v71
    ds_write_b64 v120, v[68:69] offset:12256
    v_mfma_f32_16x16x32_f16 v[64:67], v[100:103], v[42:45], 0
    v_cvt_pk_f16_f32 v72, v72, v73
    v_cvt_pk_f16_f32 v73, v74, v75
    ds_write_b64 v120, v[72:73] offset:15328
    v_mfma_f32_16x16x32_f16 v[68:71], v[96:99], v[48:51], 0
    v_cvt_pk_f16_f32 v56, v56, v57
    v_cvt_pk_f16_f32 v57, v58, v59
    ds_write_b64 v119, v[56:57] offset:1536
    v_mfma_f32_16x16x32_f16 v[72:75], v[100:103], v[48:51], 0
    v_cvt_pk_f16_f32 v60, v60, v61
    v_cvt_pk_f16_f32 v61, v62, v63
    ds_write_b64 v120, v[60:61] offset:9664
    v_cvt_pk_f16_f32 v64, v64, v65
    v_cvt_pk_f16_f32 v65, v66, v67
    ds_write_b64 v120, v[64:65] offset:12768
    v_cvt_pk_f16_f32 v68, v68, v69
    v_cvt_pk_f16_f32 v69, v70, v71
    ds_write_b64 v120, v[68:69] offset:10176
    v_cvt_pk_f16_f32 v72, v72, v73
    v_cvt_pk_f16_f32 v73, v74, v75
    ds_write_b64 v120, v[72:73] offset:13280
    v_lshl_add_u32 v4, s6, 2, v12
    s_waitcnt lgkmcnt(0)
    s_mov_b32 exec_lo, 1
    s_mov_b32 exec_hi, 0
    ds_add_u32 v4, v13 offset:224
    s_mov_b64 exec, -1
    s_setprio 3
    v_readfirstlane_b32 s59, v112
    v_ldexp_f32 v76, v76, v112
    s_sub_i32 s50, s50, s59
    s_sub_i32 s50, s50, 11
    s_max_i32 s50, s50, 1
    s_min_i32 s50, s50, 254
    s_mul_i32 s50, s50, 0x800080
    v_readfirstlane_b32 s59, v113
    v_ldexp_f32 v77, v77, v113
    s_sub_i32 s51, s51, s59
    s_sub_i32 s51, s51, 11
    s_max_i32 s51, s51, 1
    s_min_i32 s51, s51, 254
    s_mul_i32 s51, s51, 0x800080
    v_readfirstlane_b32 s59, v114
    v_ldexp_f32 v78, v78, v114
    s_sub_i32 s52, s52, s59
    s_sub_i32 s52, s52, 11
    s_max_i32 s52, s52, 1
    s_min_i32 s52, s52, 254
    s_mul_i32 s52, s52, 0x800080
    v_readfirstlane_b32 s59, v115
    v_ldexp_f32 v79, v79, v115
    s_sub_i32 s53, s53, s59
    s_sub_i32 s53, s53, 11
    s_max_i32 s53, s53, 1
    s_min_i32 s53, s53, 254
    s_mul_i32 s53, s53, 0x800080
L_eloop:
L_spin2:
    ds_read_b32 v29, v12 offset:192
    s_waitcnt lgkmcnt(0)
    v_readfirstlane_b32 s59, v29
    s_sleep 1
    s_cmp_lt_u32 s59, 4
    s_nop 1
    s_cbranch_scc1 L_spin2
    ds_read_b64 v[32:33], v123 offset:0
    ds_read_b32 v56, v124 offset:0
    ds_read_b64 v[38:39], v123 offset:2304
    ds_read_b32 v57, v124 offset:15840
    ds_read_b64 v[44:45], v123 offset:4608
    ds_read_b32 v58, v124 offset:31680
    ds_read_b64 v[50:51], v123 offset:6912
    ds_read_b32 v59, v124 offset:47520
    s_waitcnt lgkmcnt(6)
    v_fma_mix_f32 v34, v56, v76, 0 op_sel_hi:[1,0,0]
    v_fma_mix_f32 v35, v56, v76, 0 op_sel:[1,0,0] op_sel_hi:[1,0,0]
    v_cvt_pk_bf16_f32 v32, v32, v34
    v_cvt_pk_bf16_f32 v33, v33, v35
    v_dot2_f32_bf16 v32, v32, s50, 0
    v_dot2_f32_bf16 v33, v33, s50, 0
    s_waitcnt lgkmcnt(4)
    v_fma_mix_f32 v40, v57, v77, 0 op_sel_hi:[1,0,0]
    v_fma_mix_f32 v41, v57, v77, 0 op_sel:[1,0,0] op_sel_hi:[1,0,0]
    v_cvt_pk_bf16_f32 v38, v38, v40
    v_cvt_pk_bf16_f32 v39, v39, v41
    v_dot2_f32_bf16 v38, v38, s51, 0
    v_dot2_f32_bf16 v39, v39, s51, 0
    s_waitcnt lgkmcnt(2)
    v_fma_mix_f32 v46, v58, v78, 0 op_sel_hi:[1,0,0]
    v_fma_mix_f32 v47, v58, v78, 0 op_sel:[1,0,0] op_sel_hi:[1,0,0]
    v_cvt_pk_bf16_f32 v44, v44, v46
    v_cvt_pk_bf16_f32 v45, v45, v47
    v_dot2_f32_bf16 v44, v44, s52, 0
    v_dot2_f32_bf16 v45, v45, s52, 0
    s_waitcnt lgkmcnt(0)
    v_fma_mix_f32 v52, v59, v79, 0 op_sel_hi:[1,0,0]
    v_fma_mix_f32 v53, v59, v79, 0 op_sel:[1,0,0] op_sel_hi:[1,0,0]
    v_cvt_pk_bf16_f32 v50, v50, v52
    v_cvt_pk_bf16_f32 v51, v51, v53
    v_dot2_f32_bf16 v50, v50, s53, 0
    v_dot2_f32_bf16 v51, v51, s53, 0
    s_mov_b32 s54, 0
    v_cvt_pk_bf16_f32 v68, v32, v38
    v_cvt_pk_bf16_f32 v69, v44, v50
    v_cvt_pk_bf16_f32 v70, v33, v39
    v_cvt_pk_bf16_f32 v71, v45, v51
    buffer_store_dwordx2 v[68:69], v126, s[40:43], s54 offen
    buffer_store_dwordx2 v[70:71], v126, s[40:43], s54 offen offset:1280
    s_nop 1
L_spin3:
    ds_read_b32 v29, v12 offset:196
    s_waitcnt lgkmcnt(0)
    v_readfirstlane_b32 s59, v29
    s_sleep 1
    s_cmp_lt_u32 s59, 8
    s_nop 1
    s_cbranch_scc1 L_spin3
    ds_read_b64 v[32:33], v123 offset:9216
    ds_read_b64 v[36:37], v123 offset:36864
    ds_read_b32 v56, v124 offset:1536
    ds_read_b64 v[38:39], v123 offset:11520
    ds_read_b64 v[42:43], v123 offset:39168
    ds_read_b32 v57, v124 offset:17376
    ds_read_b64 v[44:45], v123 offset:13824
    ds_read_b64 v[48:49], v123 offset:41472
    ds_read_b32 v58, v124 offset:33216
    ds_read_b64 v[50:51], v123 offset:16128
    ds_read_b64 v[54:55], v123 offset:43776
    ds_read_b32 v59, v124 offset:49056
    s_waitcnt lgkmcnt(9)
    v_fma_mix_f32 v34, v56, v76, 0 op_sel_hi:[1,0,0]
    v_pk_add_f32 v[32:33], v[32:33], v[36:37]
    v_fma_mix_f32 v35, v56, v76, 0 op_sel:[1,0,0] op_sel_hi:[1,0,0]
    v_cvt_pk_bf16_f32 v32, v32, v34
    v_cvt_pk_bf16_f32 v33, v33, v35
    v_dot2_f32_bf16 v32, v32, s50, 0
    v_dot2_f32_bf16 v33, v33, s50, 0
    s_waitcnt lgkmcnt(6)
    v_fma_mix_f32 v40, v57, v77, 0 op_sel_hi:[1,0,0]
    v_pk_add_f32 v[38:39], v[38:39], v[42:43]
    v_fma_mix_f32 v41, v57, v77, 0 op_sel:[1,0,0] op_sel_hi:[1,0,0]
    v_cvt_pk_bf16_f32 v38, v38, v40
    v_cvt_pk_bf16_f32 v39, v39, v41
    v_dot2_f32_bf16 v38, v38, s51, 0
    v_dot2_f32_bf16 v39, v39, s51, 0
    s_waitcnt lgkmcnt(3)
    v_fma_mix_f32 v46, v58, v78, 0 op_sel_hi:[1,0,0]
    v_pk_add_f32 v[44:45], v[44:45], v[48:49]
    v_fma_mix_f32 v47, v58, v78, 0 op_sel:[1,0,0] op_sel_hi:[1,0,0]
    v_cvt_pk_bf16_f32 v44, v44, v46
    v_cvt_pk_bf16_f32 v45, v45, v47
    v_dot2_f32_bf16 v44, v44, s52, 0
    v_dot2_f32_bf16 v45, v45, s52, 0
    s_waitcnt lgkmcnt(0)
    v_fma_mix_f32 v52, v59, v79, 0 op_sel_hi:[1,0,0]
    v_pk_add_f32 v[50:51], v[50:51], v[54:55]
    v_fma_mix_f32 v53, v59, v79, 0 op_sel:[1,0,0] op_sel_hi:[1,0,0]
    v_cvt_pk_bf16_f32 v50, v50, v52
    v_cvt_pk_bf16_f32 v51, v51, v53
    v_dot2_f32_bf16 v50, v50, s53, 0
    v_dot2_f32_bf16 v51, v51, s53, 0
    s_mov_b32 s54, 655360
    v_cvt_pk_bf16_f32 v72, v32, v38
    v_cvt_pk_bf16_f32 v73, v44, v50
    v_cvt_pk_bf16_f32 v74, v33, v39
    v_cvt_pk_bf16_f32 v75, v45, v51
    buffer_store_dwordx2 v[72:73], v126, s[40:43], s54 offen
    buffer_store_dwordx2 v[74:75], v126, s[40:43], s54 offen offset:1280
    s_nop 1
L_spin4:
    ds_read_b32 v29, v12 offset:200
    s_waitcnt lgkmcnt(0)
    v_readfirstlane_b32 s59, v29
    s_sleep 1
    s_cmp_lt_u32 s59, 8
    s_nop 1
    s_cbranch_scc1 L_spin4
    ds_read_b64 v[32:33], v123 offset:18432
    ds_read_b64 v[36:37], v125 offset:4992
    ds_read_b32 v56, v124 offset:3072
    ds_read_b64 v[38:39], v123 offset:20736
    ds_read_b64 v[42:43], v125 offset:14976
    ds_read_b32 v57, v124 offset:18912
    ds_read_b64 v[44:45], v123 offset:23040
    ds_read_b64 v[48:49], v125 offset:24960
    ds_read_b32 v58, v124 offset:34752
    ds_read_b64 v[50:51], v123 offset:25344
    ds_read_b64 v[54:55], v125 offset:34944
    ds_read_b32 v59, v124 offset:50592
    s_waitcnt lgkmcnt(9)
    v_fma_mix_f32 v34, v56, v76, 0 op_sel_hi:[1,0,0]
    v_pk_add_f32 v[32:33], v[32:33], v[36:37]
    v_fma_mix_f32 v35, v56, v76, 0 op_sel:[1,0,0] op_sel_hi:[1,0,0]
    v_cvt_pk_bf16_f32 v32, v32, v34
    v_cvt_pk_bf16_f32 v33, v33, v35
    v_dot2_f32_bf16 v32, v32, s50, 0
    v_dot2_f32_bf16 v33, v33, s50, 0
    s_waitcnt lgkmcnt(6)
    v_fma_mix_f32 v40, v57, v77, 0 op_sel_hi:[1,0,0]
    v_pk_add_f32 v[38:39], v[38:39], v[42:43]
    v_fma_mix_f32 v41, v57, v77, 0 op_sel:[1,0,0] op_sel_hi:[1,0,0]
    v_cvt_pk_bf16_f32 v38, v38, v40
    v_cvt_pk_bf16_f32 v39, v39, v41
    v_dot2_f32_bf16 v38, v38, s51, 0
    v_dot2_f32_bf16 v39, v39, s51, 0
    s_waitcnt lgkmcnt(3)
    v_fma_mix_f32 v46, v58, v78, 0 op_sel_hi:[1,0,0]
    v_pk_add_f32 v[44:45], v[44:45], v[48:49]
    v_fma_mix_f32 v47, v58, v78, 0 op_sel:[1,0,0] op_sel_hi:[1,0,0]
    v_cvt_pk_bf16_f32 v44, v44, v46
    v_cvt_pk_bf16_f32 v45, v45, v47
    v_dot2_f32_bf16 v44, v44, s52, 0
    v_dot2_f32_bf16 v45, v45, s52, 0
    s_waitcnt lgkmcnt(0)
    v_fma_mix_f32 v52, v59, v79, 0 op_sel_hi:[1,0,0]
    v_pk_add_f32 v[50:51], v[50:51], v[54:55]
    v_fma_mix_f32 v53, v59, v79, 0 op_sel:[1,0,0] op_sel_hi:[1,0,0]
    v_cvt_pk_bf16_f32 v50, v50, v52
    v_cvt_pk_bf16_f32 v51, v51, v53
    v_dot2_f32_bf16 v50, v50, s53, 0
    v_dot2_f32_bf16 v51, v51, s53, 0
    s_mov_b32 s54, 1310720
    v_cvt_pk_bf16_f32 v68, v32, v38
    v_cvt_pk_bf16_f32 v69, v44, v50
    v_cvt_pk_bf16_f32 v70, v33, v39
    v_cvt_pk_bf16_f32 v71, v45, v51
    buffer_store_dwordx2 v[68:69], v126, s[40:43], s54 offen
    buffer_store_dwordx2 v[70:71], v126, s[40:43], s54 offen offset:1280
    s_nop 1
L_spin5:
    ds_read_b32 v29, v12 offset:204
    s_waitcnt lgkmcnt(0)
    v_readfirstlane_b32 s59, v29
    s_sleep 1
    s_cmp_lt_u32 s59, 8
    s_nop 1
    s_cbranch_scc1 L_spin5
    ds_read_b64 v[32:33], v123 offset:27648
    ds_read_b64 v[36:37], v125 offset:7296
    ds_read_b32 v56, v124 offset:4608
    ds_read_b64 v[38:39], v123 offset:29952
    ds_read_b64 v[42:43], v125 offset:17280
    ds_read_b32 v57, v124 offset:20448
    ds_read_b64 v[44:45], v123 offset:32256
    ds_read_b64 v[48:49], v125 offset:27264
    ds_read_b32 v58, v124 offset:36288
    ds_read_b64 v[50:51], v123 offset:34560
    ds_read_b64 v[54:55], v125 offset:37248
    ds_read_b32 v59, v124 offset:52128
    s_waitcnt lgkmcnt(9)
    v_fma_mix_f32 v34, v56, v76, 0 op_sel_hi:[1,0,0]
    v_pk_add_f32 v[32:33], v[32:33], v[36:37]
    v_fma_mix_f32 v35, v56, v76, 0 op_sel:[1,0,0] op_sel_hi:[1,0,0]
    v_cvt_pk_bf16_f32 v32, v32, v34
    v_cvt_pk_bf16_f32 v33, v33, v35
    v_dot2_f32_bf16 v32, v32, s50, 0
    v_dot2_f32_bf16 v33, v33, s50, 0
    s_waitcnt lgkmcnt(6)
    v_fma_mix_f32 v40, v57, v77, 0 op_sel_hi:[1,0,0]
    v_pk_add_f32 v[38:39], v[38:39], v[42:43]
    v_fma_mix_f32 v41, v57, v77, 0 op_sel:[1,0,0] op_sel_hi:[1,0,0]
    v_cvt_pk_bf16_f32 v38, v38, v40
    v_cvt_pk_bf16_f32 v39, v39, v41
    v_dot2_f32_bf16 v38, v38, s51, 0
    v_dot2_f32_bf16 v39, v39, s51, 0
    s_waitcnt lgkmcnt(3)
    v_fma_mix_f32 v46, v58, v78, 0 op_sel_hi:[1,0,0]
    v_pk_add_f32 v[44:45], v[44:45], v[48:49]
    v_fma_mix_f32 v47, v58, v78, 0 op_sel:[1,0,0] op_sel_hi:[1,0,0]
    v_cvt_pk_bf16_f32 v44, v44, v46
    v_cvt_pk_bf16_f32 v45, v45, v47
    v_dot2_f32_bf16 v44, v44, s52, 0
    v_dot2_f32_bf16 v45, v45, s52, 0
    s_waitcnt lgkmcnt(0)
    v_fma_mix_f32 v52, v59, v79, 0 op_sel_hi:[1,0,0]
    v_pk_add_f32 v[50:51], v[50:51], v[54:55]
    v_fma_mix_f32 v53, v59, v79, 0 op_sel:[1,0,0] op_sel_hi:[1,0,0]
    v_cvt_pk_bf16_f32 v50, v50, v52
    v_cvt_pk_bf16_f32 v51, v51, v53
    v_dot2_f32_bf16 v50, v50, s53, 0
    v_dot2_f32_bf16 v51, v51, s53, 0
    s_mov_b32 s54, 1966080
    v_cvt_pk_bf16_f32 v72, v32, v38
    v_cvt_pk_bf16_f32 v73, v44, v50
    v_cvt_pk_bf16_f32 v74, v33, v39
    v_cvt_pk_bf16_f32 v75, v45, v51
    buffer_store_dwordx2 v[72:73], v126, s[40:43], s54 offen
    buffer_store_dwordx2 v[74:75], v126, s[40:43], s54 offen offset:1280
    s_waitcnt vmcnt(0)
    s_branch L_end
L_B0:
    s_waitcnt lgkmcnt(0)
    s_barrier
    v_and_b32 v8, 15, v1
    v_lshrrev_b32_e64 v9, 4, v1
    s_mul_i32 s46, s6, 9984
    s_add_u32 s46, s46, 54912
    v_sub_u32 v10, 1, v8
    v_and_b32 v10, 1, v10
    v_mul_u32_u24 v11, 2496, v10
    v_add_u32 v10, v10, v8
    v_lshlrev_b32 v12, 2, v9
    v_sub_u32_e64 v10, v12, v10
    v_lshl_add_u32 v11, v10, 1, v11
    v_add3_u32 v11, s46, v11, 2
    s_mul_i32 s47, s6, 15840
    s_add_u32 s47, s47, 94848
    s_mul_i32 s48, s6, 2304
    s_cmp_eq_u32 s7, 2
    s_cbranch_scc1 L_roleC
    s_cmp_eq_u32 s7, 1
    s_cbranch_scc1 L_roleB
    v_mul_u32_u24 v12, 96, v8
    v_lshl_add_u32 v12, v9, 4, v12
    v_add_u32 v12, s47, v12
    v_mov_b32 v14, v11
    v_add_u32 v11, 256, v11
    v_lshl_add_u32 v10, v1, 4, s46
    ds_read_b128 v[104:107], v12 offset:1440
    ds_read2_b32 v[102:103], v11 offset0:231 offset1:232
    ds_read2_b32 v[100:101], v11 offset0:223 offset1:224
    ds_read_b128 v[108:111], v12 offset:1344
    ds_read2_b32 v[98:99], v11 offset0:215 offset1:216
    ds_read2_b32 v[96:97], v11 offset0:207 offset1:208
    ds_read_b128 v[112:115], v12 offset:1248
    ds_read2_b32 v[94:95], v11 offset0:199 offset1:200
    ds_read2_b32 v[92:93], v11 offset0:191 offset1:192
    ds_read_b128 v[0:3], v12 offset:1152
    ds_read2_b32 v[90:91], v11 offset0:183 offset1:184
    ds_read2_b32 v[88:89], v11 offset0:175 offset1:176
    ds_read2_b32 v[86:87], v11 offset0:167 offset1:168
    v_mul_u32_u24 v13, 144, v8
    v_lshl_add_u32 v13, v9, 4, v13
    v_add_u32_e64 v13, s48, v13
    v_mov_b32 v9, 158208
    v_lshl_add_u32 v9, s6, 2, v9
    v_mov_b32 v15, 1
    s_setprio 3
    s_waitcnt lgkmcnt(8)
    v_mfma_f32_16x16x32_f16 v[116:119], v[100:103], v[104:107], 0
    v_mfma_f32_16x16x32_f16 v[120:123], v[98:101], v[104:107], 0
    ds_read2_b32 v[84:85], v11 offset0:159 offset1:160
    ds_read2_b32 v[82:83], v11 offset0:151 offset1:152
    ds_read_b128 v[4:7], v12 offset:1056
    s_waitcnt lgkmcnt(8)
    v_mfma_f32_16x16x32_f16 v[116:119], v[96:99], v[108:111], v[116:119]
    v_mfma_f32_16x16x32_f16 v[120:123], v[94:97], v[108:111], v[120:123]
    ds_read2_b32 v[80:81], v11 offset0:143 offset1:144
    ds_read2_b32 v[78:79], v11 offset0:135 offset1:136
    ds_read_b128 v[16:19], v12 offset:960
    s_waitcnt lgkmcnt(8)
    v_mfma_f32_16x16x32_f16 v[116:119], v[92:95], v[112:115], v[116:119]
    v_mfma_f32_16x16x32_f16 v[120:123], v[90:93], v[112:115], v[120:123]
    ds_read2_b32 v[76:77], v11 offset0:127 offset1:128
    ds_read2_b32 v[74:75], v11 offset0:119 offset1:120
    ds_read_b128 v[20:23], v12 offset:864
    s_waitcnt lgkmcnt(9)
    v_mfma_f32_16x16x32_f16 v[116:119], v[88:91], v[0:3], v[116:119]
    v_mfma_f32_16x16x32_f16 v[120:123], v[86:89], v[0:3], v[120:123]
    ds_read2_b32 v[72:73], v11 offset0:111 offset1:112
    ds_read2_b32 v[70:71], v11 offset0:103 offset1:104
    ds_read_b128 v[24:27], v12 offset:768
    s_waitcnt lgkmcnt(9)
    v_mfma_f32_16x16x32_f16 v[116:119], v[84:87], v[4:7], v[116:119]
    v_mfma_f32_16x16x32_f16 v[120:123], v[82:85], v[4:7], v[120:123]
    ds_read2_b32 v[68:69], v11 offset0:95 offset1:96
    ds_read2_b32 v[66:67], v11 offset0:87 offset1:88
    ds_read_b128 v[28:31], v12 offset:672
    s_waitcnt lgkmcnt(9)
    v_mfma_f32_16x16x32_f16 v[116:119], v[80:83], v[16:19], v[116:119]
    v_mfma_f32_16x16x32_f16 v[120:123], v[78:81], v[16:19], v[120:123]
    ds_read2_b32 v[64:65], v11 offset0:79 offset1:80
    ds_read2_b32 v[62:63], v11 offset0:71 offset1:72
    ds_read_b128 v[124:127], v12 offset:576
    s_waitcnt lgkmcnt(9)
    v_mfma_f32_16x16x32_f16 v[116:119], v[76:79], v[20:23], v[116:119]
    v_mfma_f32_16x16x32_f16 v[120:123], v[74:77], v[20:23], v[120:123]
    ds_read2_b32 v[60:61], v11 offset0:63 offset1:64
    ds_read2_b32 v[58:59], v11 offset0:55 offset1:56
    ds_read_b128 v[104:107], v12 offset:480
    s_waitcnt lgkmcnt(9)
    v_mfma_f32_16x16x32_f16 v[116:119], v[72:75], v[24:27], v[116:119]
    v_mfma_f32_16x16x32_f16 v[120:123], v[70:73], v[24:27], v[120:123]
    ds_read2_b32 v[56:57], v11 offset0:47 offset1:48
    ds_read2_b32 v[54:55], v11 offset0:39 offset1:40
    ds_read_b128 v[108:111], v12 offset:384
    s_waitcnt lgkmcnt(9)
    v_mfma_f32_16x16x32_f16 v[116:119], v[68:71], v[28:31], v[116:119]
    v_mfma_f32_16x16x32_f16 v[120:123], v[66:69], v[28:31], v[120:123]
    ds_read2_b32 v[52:53], v11 offset0:31 offset1:32
    ds_read2_b32 v[50:51], v11 offset0:23 offset1:24
    ds_read_b128 v[112:115], v12 offset:288
    s_waitcnt lgkmcnt(9)
    v_mfma_f32_16x16x32_f16 v[116:119], v[64:67], v[124:127], v[116:119]
    v_mfma_f32_16x16x32_f16 v[120:123], v[62:65], v[124:127], v[120:123]
    ds_read2_b32 v[48:49], v11 offset0:15 offset1:16
    ds_read2_b32 v[46:47], v11 offset0:7 offset1:8
    ds_read_b128 v[0:3], v12 offset:192
    s_waitcnt lgkmcnt(9)
    v_mfma_f32_16x16x32_f16 v[116:119], v[60:63], v[104:107], v[116:119]
    v_mfma_f32_16x16x32_f16 v[120:123], v[58:61], v[104:107], v[120:123]
    ds_read2_b32 v[44:45], v14 offset0:63 offset1:64
    ds_read2_b32 v[42:43], v14 offset0:55 offset1:56
    ds_read_b128 v[4:7], v12 offset:96
    s_waitcnt lgkmcnt(9)
    v_mfma_f32_16x16x32_f16 v[116:119], v[56:59], v[108:111], v[116:119]
    v_mfma_f32_16x16x32_f16 v[120:123], v[54:57], v[108:111], v[120:123]
    ds_read2_b32 v[40:41], v14 offset0:47 offset1:48
    ds_read2_b32 v[38:39], v14 offset0:39 offset1:40
    ds_read_b128 v[16:19], v12 offset:0
    s_waitcnt lgkmcnt(9)
    v_mfma_f32_16x16x32_f16 v[116:119], v[52:55], v[112:115], v[116:119]
    v_mfma_f32_16x16x32_f16 v[120:123], v[50:53], v[112:115], v[120:123]
    ds_read2_b32 v[36:37], v14 offset0:31 offset1:32
    ds_read2_b32 v[34:35], v14 offset0:23 offset1:24
    ds_read_b128 v[20:23], v12 offset:2976
    s_waitcnt lgkmcnt(9)
    v_mfma_f32_16x16x32_f16 v[116:119], v[48:51], v[0:3], v[116:119]
    v_mfma_f32_16x16x32_f16 v[120:123], v[46:49], v[0:3], v[120:123]
    ds_read2_b32 v[32:33], v14 offset0:15 offset1:16
    s_mov_b32 exec_lo, 1
    s_mov_b32 exec_hi, 0
    ds_add_u32 v9, v15 offset:128
    s_mov_b64 exec, -1
    ds_read_b128 v[24:27], v12 offset:2880
    s_waitcnt lgkmcnt(9)
    v_mfma_f32_16x16x32_f16 v[116:119], v[44:47], v[4:7], v[116:119]
    v_mfma_f32_16x16x32_f16 v[120:123], v[42:45], v[4:7], v[120:123]
    ds_read_b128 v[28:31], v12 offset:2784
    ds_read_b128 v[124:127], v12 offset:2688
    ds_read_b128 v[104:107], v12 offset:2592
    s_waitcnt lgkmcnt(9)
    v_mfma_f32_16x16x32_f16 v[116:119], v[40:43], v[16:19], v[116:119]
    v_mfma_f32_16x16x32_f16 v[120:123], v[38:41], v[16:19], v[120:123]
    ds_read_b128 v[108:111], v12 offset:2496
    ds_read_b128 v[112:115], v12 offset:2400
    ds_read_b128 v[0:3], v12 offset:2304
    s_nop 3
    ds_write_b128 v13, v[116:119] offset:0
    ds_write_b128 v13, v[120:123] offset:64
    v_mov_b32 v14, 158208
    s_mov_b32 exec_lo, 1
    s_mov_b32 exec_hi, 0
    ds_add_u32 v14, v15 offset:192
    s_mov_b64 exec, -1
    s_setprio 2
    s_waitcnt lgkmcnt(12)
    v_mfma_f32_16x16x32_f16 v[116:119], v[100:103], v[20:23], 0
    v_mfma_f32_16x16x32_f16 v[120:123], v[98:101], v[20:23], 0
    s_waitcnt lgkmcnt(9)
    v_mfma_f32_16x16x32_f16 v[116:119], v[96:99], v[24:27], v[116:119]
    v_mfma_f32_16x16x32_f16 v[120:123], v[94:97], v[24:27], v[120:123]
    ds_read_b128 v[4:7], v12 offset:2208
    ds_read_b128 v[16:19], v12 offset:2112
    ds_read_b128 v[20:23], v12 offset:2016
    s_waitcnt lgkmcnt(11)
    v_mfma_f32_16x16x32_f16 v[116:119], v[92:95], v[28:31], v[116:119]
    v_mfma_f32_16x16x32_f16 v[120:123], v[90:93], v[28:31], v[120:123]
    ds_read_b128 v[24:27], v12 offset:1920
    ds_read_b32 v8, v9 offset:144
    s_waitcnt lgkmcnt(12)
    v_mfma_f32_16x16x32_f16 v[116:119], v[88:91], v[124:127], v[116:119]
    v_mfma_f32_16x16x32_f16 v[120:123], v[86:89], v[124:127], v[120:123]
    s_waitcnt lgkmcnt(11)
    v_mfma_f32_16x16x32_f16 v[116:119], v[84:87], v[104:107], v[116:119]
    v_mfma_f32_16x16x32_f16 v[120:123], v[82:85], v[104:107], v[120:123]
    ds_read_b128 v[28:31], v12 offset:1824
    s_waitcnt lgkmcnt(11)
    v_mfma_f32_16x16x32_f16 v[116:119], v[80:83], v[108:111], v[116:119]
    v_mfma_f32_16x16x32_f16 v[120:123], v[78:81], v[108:111], v[120:123]
    ds_read_b128 v[124:127], v12 offset:1728
    s_waitcnt lgkmcnt(11)
    v_mfma_f32_16x16x32_f16 v[116:119], v[76:79], v[112:115], v[116:119]
    v_mfma_f32_16x16x32_f16 v[120:123], v[74:77], v[112:115], v[120:123]
    ds_read_b128 v[104:107], v12 offset:1632
    s_waitcnt lgkmcnt(11)
    v_mfma_f32_16x16x32_f16 v[116:119], v[72:75], v[0:3], v[116:119]
    v_mfma_f32_16x16x32_f16 v[120:123], v[70:73], v[0:3], v[120:123]
    ds_read_b128 v[108:111], v12 offset:1536
    s_waitcnt lgkmcnt(8)
    v_mfma_f32_16x16x32_f16 v[116:119], v[68:71], v[4:7], v[116:119]
    v_mfma_f32_16x16x32_f16 v[120:123], v[66:69], v[4:7], v[120:123]
    ds_read_b128 v[112:115], v12 offset:1440
    ds_read_b128 v[0:3], v12 offset:1344
    ds_read_b128 v[4:7], v12 offset:4512
    s_waitcnt lgkmcnt(10)
    v_mfma_f32_16x16x32_f16 v[116:119], v[64:67], v[16:19], v[116:119]
    v_mfma_f32_16x16x32_f16 v[120:123], v[62:65], v[16:19], v[120:123]
    ds_read_b128 v[16:19], v12 offset:4416
    s_waitcnt lgkmcnt(10)
    v_mfma_f32_16x16x32_f16 v[116:119], v[60:63], v[20:23], v[116:119]
    v_mfma_f32_16x16x32_f16 v[120:123], v[58:61], v[20:23], v[120:123]
    ds_read_b128 v[20:23], v12 offset:4320
    s_waitcnt lgkmcnt(10)
    v_mfma_f32_16x16x32_f16 v[116:119], v[56:59], v[24:27], v[116:119]
    v_mfma_f32_16x16x32_f16 v[120:123], v[54:57], v[24:27], v[120:123]
    ds_read_b128 v[24:27], v12 offset:4224
    s_waitcnt lgkmcnt(9)
    v_mfma_f32_16x16x32_f16 v[116:119], v[52:55], v[28:31], v[116:119]
    v_mfma_f32_16x16x32_f16 v[120:123], v[50:53], v[28:31], v[120:123]
    ds_read_b128 v[28:31], v12 offset:4128
    s_waitcnt lgkmcnt(9)
    v_mfma_f32_16x16x32_f16 v[116:119], v[48:51], v[124:127], v[116:119]
    v_mfma_f32_16x16x32_f16 v[120:123], v[46:49], v[124:127], v[120:123]
    ds_read_b128 v[124:127], v12 offset:4032
    s_waitcnt lgkmcnt(9)
    v_mfma_f32_16x16x32_f16 v[116:119], v[44:47], v[104:107], v[116:119]
    v_mfma_f32_16x16x32_f16 v[120:123], v[42:45], v[104:107], v[120:123]
    ds_read_b128 v[104:107], v12 offset:3936
    s_waitcnt lgkmcnt(9)
    v_mfma_f32_16x16x32_f16 v[116:119], v[40:43], v[108:111], v[116:119]
    v_mfma_f32_16x16x32_f16 v[120:123], v[38:41], v[108:111], v[120:123]
    ds_read_b128 v[108:111], v12 offset:3840
    s_waitcnt lgkmcnt(9)
    v_mfma_f32_16x16x32_f16 v[116:119], v[36:39], v[112:115], v[116:119]
    v_mfma_f32_16x16x32_f16 v[120:123], v[34:37], v[112:115], v[120:123]
    ds_read_b128 v[112:115], v12 offset:3744
    s_waitcnt lgkmcnt(9)
    v_mfma_f32_16x16x32_f16 v[116:119], v[32:35], v[0:3], v[116:119]
    ds_read_b128 v[0:3], v12 offset:3648
    s_nop 6
    ds_write_b128 v13, v[116:119] offset:9216
    ds_write_b128 v13, v[120:123] offset:9280
    v_mov_b32 v14, 158208
    s_mov_b32 exec_lo, 1
    s_mov_b32 exec_hi, 0
    ds_add_u32 v14, v15 offset:196
    s_mov_b64 exec, -1
    s_setprio 1
    s_waitcnt lgkmcnt(12)
    v_mfma_f32_16x16x32_f16 v[116:119], v[100:103], v[4:7], 0
    v_mfma_f32_16x16x32_f16 v[120:123], v[98:101], v[4:7], 0
    s_waitcnt lgkmcnt(11)
    v_mfma_f32_16x16x32_f16 v[116:119], v[96:99], v[16:19], v[116:119]
    v_mfma_f32_16x16x32_f16 v[120:123], v[94:97], v[16:19], v[120:123]
    ds_read_b128 v[4:7], v12 offset:3552
    s_waitcnt lgkmcnt(11)
    v_mfma_f32_16x16x32_f16 v[116:119], v[92:95], v[20:23], v[116:119]
    v_mfma_f32_16x16x32_f16 v[120:123], v[90:93], v[20:23], v[120:123]
    ds_read_b128 v[16:19], v12 offset:3456
    s_waitcnt lgkmcnt(11)
    v_mfma_f32_16x16x32_f16 v[116:119], v[88:91], v[24:27], v[116:119]
    v_mfma_f32_16x16x32_f16 v[120:123], v[86:89], v[24:27], v[120:123]
    ds_read_b128 v[20:23], v12 offset:3360
    s_waitcnt lgkmcnt(11)
    v_mfma_f32_16x16x32_f16 v[116:119], v[84:87], v[28:31], v[116:119]
    v_mfma_f32_16x16x32_f16 v[120:123], v[82:85], v[28:31], v[120:123]
    ds_read_b128 v[24:27], v12 offset:3264
    s_waitcnt lgkmcnt(11)
    v_mfma_f32_16x16x32_f16 v[116:119], v[80:83], v[124:127], v[116:119]
    v_mfma_f32_16x16x32_f16 v[120:123], v[78:81], v[124:127], v[120:123]
    ds_read_b128 v[28:31], v12 offset:3168
    s_waitcnt lgkmcnt(11)
    v_mfma_f32_16x16x32_f16 v[116:119], v[76:79], v[104:107], v[116:119]
    v_mfma_f32_16x16x32_f16 v[120:123], v[74:77], v[104:107], v[120:123]
    ds_read_b128 v[124:127], v12 offset:3072
    s_waitcnt lgkmcnt(11)
    v_mfma_f32_16x16x32_f16 v[116:119], v[72:75], v[108:111], v[116:119]
    v_mfma_f32_16x16x32_f16 v[120:123], v[70:73], v[108:111], v[120:123]
    ds_read_b128 v[104:107], v12 offset:2976
    s_waitcnt lgkmcnt(11)
    v_mfma_f32_16x16x32_f16 v[116:119], v[68:71], v[112:115], v[116:119]
    v_mfma_f32_16x16x32_f16 v[120:123], v[66:69], v[112:115], v[120:123]
    ds_read_b128 v[108:111], v12 offset:2880
    s_waitcnt lgkmcnt(11)
    v_mfma_f32_16x16x32_f16 v[116:119], v[64:67], v[0:3], v[116:119]
    v_mfma_f32_16x16x32_f16 v[120:123], v[62:65], v[0:3], v[120:123]
    v_readfirstlane_b32 s59, v8
    s_cmp_lt_u32 s59, 1
    s_nop 4
    s_cbranch_scc1 L_gs_fixg
L_gr_fixg:
    ds_read_b128 v[112:115], v10
    s_waitcnt lgkmcnt(8)
    v_mfma_f32_16x16x32_f16 v[116:119], v[60:63], v[4:7], v[116:119]
    v_mfma_f32_16x16x32_f16 v[120:123], v[58:61], v[4:7], v[120:123]
    ds_read_b128 v[0:3], v10 offset:1024
    ds_read_b128 v[4:7], v12 offset:1440
    s_waitcnt lgkmcnt(9)
    v_mfma_f32_16x16x32_f16 v[116:119], v[56:59], v[16:19], v[116:119]
    v_mfma_f32_16x16x32_f16 v[120:123], v[54:57], v[16:19], v[120:123]
    ds_read_b128 v[16:19], v10 offset:2048
    s_waitcnt lgkmcnt(9)
    v_mfma_f32_16x16x32_f16 v[116:119], v[52:55], v[20:23], v[116:119]
    v_mfma_f32_16x16x32_f16 v[120:123], v[50:53], v[20:23], v[120:123]
    ds_read_b128 v[20:23], v12 offset:1344
    s_waitcnt lgkmcnt(9)
    v_mfma_f32_16x16x32_f16 v[116:119], v[48:51], v[24:27], v[116:119]
    v_mfma_f32_16x16x32_f16 v[120:123], v[46:49], v[24:27], v[120:123]
    ds_read_b128 v[24:27], v12 offset:6048
    s_waitcnt lgkmcnt(9)
    v_mfma_f32_16x16x32_f16 v[116:119], v[44:47], v[28:31], v[116:119]
    v_mfma_f32_16x16x32_f16 v[120:123], v[42:45], v[28:31], v[120:123]
    ds_read_b128 v[28:31], v12 offset:5952
    s_waitcnt lgkmcnt(9)
    v_mfma_f32_16x16x32_f16 v[116:119], v[40:43], v[124:127], v[116:119]
    v_mfma_f32_16x16x32_f16 v[120:123], v[38:41], v[124:127], v[120:123]
    ds_read_b128 v[124:127], v12 offset:5856
    s_waitcnt lgkmcnt(9)
    v_mfma_f32_16x16x32_f16 v[116:119], v[36:39], v[104:107], v[116:119]
    v_mfma_f32_16x16x32_f16 v[120:123], v[34:37], v[104:107], v[120:123]
    ds_read_b128 v[104:107], v12 offset:5760
    s_waitcnt lgkmcnt(9)
    v_mfma_f32_16x16x32_f16 v[116:119], v[32:35], v[108:111], v[116:119]
    ds_read_b128 v[108:111], v12 offset:5664
    s_waitcnt lgkmcnt(7)
    v_mfma_f32_16x16x32_f16 v[116:119], v[112:115], v[4:7], v[116:119]
    v_mfma_f32_16x16x32_f16 v[120:123], v[0:3], v[4:7], v[120:123]
    ds_read_b128 v[112:115], v12 offset:5568
    ds_read_b128 v[0:3], v12 offset:5472
    ds_read_b128 v[4:7], v12 offset:5376
    s_waitcnt lgkmcnt(8)
    v_mfma_f32_16x16x32_f16 v[116:119], v[16:19], v[20:23], v[116:119]
    ds_read_b128 v[16:19], v12 offset:5280
    ds_read_b128 v[20:23], v12 offset:5184
    s_nop 5
    ds_write_b128 v13, v[116:119] offset:18432
    ds_write_b128 v13, v[120:123] offset:18496
    v_mov_b32 v14, 158208
    s_mov_b32 exec_lo, 1
    s_mov_b32 exec_hi, 0
    ds_add_u32 v14, v15 offset:200
    s_mov_b64 exec, -1
    s_setprio 0
    s_waitcnt lgkmcnt(12)
    v_mfma_f32_16x16x32_f16 v[116:119], v[100:103], v[24:27], 0
    v_mfma_f32_16x16x32_f16 v[120:123], v[98:101], v[24:27], 0
    s_waitcnt lgkmcnt(11)
    v_mfma_f32_16x16x32_f16 v[116:119], v[96:99], v[28:31], v[116:119]
    v_mfma_f32_16x16x32_f16 v[120:123], v[94:97], v[28:31], v[120:123]
    ds_read_b128 v[24:27], v12 offset:5088
    s_waitcnt lgkmcnt(11)
    v_mfma_f32_16x16x32_f16 v[116:119], v[92:95], v[124:127], v[116:119]
    v_mfma_f32_16x16x32_f16 v[120:123], v[90:93], v[124:127], v[120:123]
    ds_read_b128 v[28:31], v12 offset:4992
    s_waitcnt lgkmcnt(11)
    v_mfma_f32_16x16x32_f16 v[116:119], v[88:91], v[104:107], v[116:119]
    v_mfma_f32_16x16x32_f16 v[120:123], v[86:89], v[104:107], v[120:123]
    ds_read_b128 v[124:127], v12 offset:4896
    s_waitcnt lgkmcnt(11)
    v_mfma_f32_16x16x32_f16 v[116:119], v[84:87], v[108:111], v[116:119]
    v_mfma_f32_16x16x32_f16 v[120:123], v[82:85], v[108:111], v[120:123]
    ds_read_b128 v[104:107], v12 offset:4800
    s_waitcnt lgkmcnt(11)
    v_mfma_f32_16x16x32_f16 v[116:119], v[80:83], v[112:115], v[116:119]
    v_mfma_f32_16x16x32_f16 v[120:123], v[78:81], v[112:115], v[120:123]
    ds_read_b128 v[108:111], v12 offset:4704
    s_waitcnt lgkmcnt(11)
    v_mfma_f32_16x16x32_f16 v[116:119], v[76:79], v[0:3], v[116:119]
    v_mfma_f32_16x16x32_f16 v[120:123], v[74:77], v[0:3], v[120:123]
    ds_read_b128 v[112:115], v12 offset:4608
    s_waitcnt lgkmcnt(11)
    v_mfma_f32_16x16x32_f16 v[116:119], v[72:75], v[4:7], v[116:119]
    v_mfma_f32_16x16x32_f16 v[120:123], v[70:73], v[4:7], v[120:123]
    ds_read_b128 v[0:3], v12 offset:4512
    s_waitcnt lgkmcnt(11)
    v_mfma_f32_16x16x32_f16 v[116:119], v[68:71], v[16:19], v[116:119]
    v_mfma_f32_16x16x32_f16 v[120:123], v[66:69], v[16:19], v[120:123]
    ds_read_b128 v[4:7], v12 offset:4416
    s_waitcnt lgkmcnt(11)
    v_mfma_f32_16x16x32_f16 v[116:119], v[64:67], v[20:23], v[116:119]
    v_mfma_f32_16x16x32_f16 v[120:123], v[62:65], v[20:23], v[120:123]
    ds_read_b128 v[16:19], v10
    s_waitcnt lgkmcnt(8)
    v_mfma_f32_16x16x32_f16 v[116:119], v[60:63], v[24:27], v[116:119]
    v_mfma_f32_16x16x32_f16 v[120:123], v[58:61], v[24:27], v[120:123]
    ds_read_b128 v[20:23], v10 offset:1024
    ds_read_b128 v[24:27], v12 offset:2976
    s_waitcnt lgkmcnt(9)
    v_mfma_f32_16x16x32_f16 v[116:119], v[56:59], v[28:31], v[116:119]
    v_mfma_f32_16x16x32_f16 v[120:123], v[54:57], v[28:31], v[120:123]
    ds_read_b128 v[28:31], v10 offset:2048
    s_waitcnt lgkmcnt(9)
    v_mfma_f32_16x16x32_f16 v[116:119], v[52:55], v[124:127], v[116:119]
    v_mfma_f32_16x16x32_f16 v[120:123], v[50:53], v[124:127], v[120:123]
    ds_read_b128 v[124:127], v12 offset:2880
    s_waitcnt lgkmcnt(9)
    v_mfma_f32_16x16x32_f16 v[116:119], v[48:51], v[104:107], v[116:119]
    v_mfma_f32_16x16x32_f16 v[120:123], v[46:49], v[104:107], v[120:123]
    s_waitcnt lgkmcnt(8)
    v_mfma_f32_16x16x32_f16 v[116:119], v[44:47], v[108:111], v[116:119]
    v_mfma_f32_16x16x32_f16 v[120:123], v[42:45], v[108:111], v[120:123]
    s_waitcnt lgkmcnt(7)
    v_mfma_f32_16x16x32_f16 v[116:119], v[40:43], v[112:115], v[116:119]
    v_mfma_f32_16x16x32_f16 v[120:123], v[38:41], v[112:115], v[120:123]
    s_waitcnt lgkmcnt(6)
    v_mfma_f32_16x16x32_f16 v[116:119], v[36:39], v[0:3], v[116:119]
    v_mfma_f32_16x16x32_f16 v[120:123], v[34:37], v[0:3], v[120:123]
    s_waitcnt lgkmcnt(5)
    v_mfma_f32_16x16x32_f16 v[116:119], v[32:35], v[4:7], v[116:119]
    s_waitcnt lgkmcnt(2)
    v_mfma_f32_16x16x32_f16 v[116:119], v[16:19], v[24:27], v[116:119]
    v_mfma_f32_16x16x32_f16 v[120:123], v[20:23], v[24:27], v[120:123]
    s_waitcnt lgkmcnt(0)
    v_mfma_f32_16x16x32_f16 v[116:119], v[28:31], v[124:127], v[116:119]
    s_nop 7
    ds_write_b128 v13, v[116:119] offset:27648
    ds_write_b128 v13, v[120:123] offset:27712
    v_mov_b32 v14, 158208
    s_mov_b32 exec_lo, 1
    s_mov_b32 exec_hi, 0
    ds_add_u32 v14, v15 offset:204
    s_mov_b64 exec, -1
    s_branch L_end
L_roleB:
    s_lshl_b32 s49, s6, 4
    s_add_u32 s49, s49, 158272
    v_mov_b32_e64 v30, s49
    ds_read_b32 v30, v30
    v_lshlrev_b32 v28, v8, 1
    v_lshlrev_b32_e64 v29, 2, v9
    v_lshl_add_u32 v10, v1, 4, s46
    v_mov_b32 v9, 158208
    v_lshl_add_u32 v9, s6, 2, v9
    v_mov_b32 v15, 1
    v_lshrrev_b32 v31, 5, v28
    v_lshrrev_b32_e64 v31, v29, v31
    v_bfe_u32 v16, v31, 0, 2
    v_lshl_or_b32 v16, v16, 15, v16
    v_and_b32 v16, 0x10001, v16
    v_bfe_u32 v17, v31, 2, 2
    v_lshl_or_b32 v17, v17, 15, v17
    v_and_b32 v17, 0x10001, v17
    v_bfe_u32 v18, v31, 16, 2
    v_lshl_or_b32 v18, v18, 15, v18
    v_and_b32 v18, 0x10001, v18
    v_bfe_u32 v19, v31, 18, 2
    v_lshl_or_b32 v19, v19, 15, v19
    v_and_b32 v19, 0x10001, v19
    v_lshlrev_b32 v31, 11, v28
    v_lshrrev_b32 v31, v29, v31
    v_bfe_u32 v20, v31, 0, 2
    v_lshl_or_b32 v20, v20, 15, v20
    v_and_b32 v20, 0x10001, v20
    v_bfe_u32 v21, v31, 2, 2
    v_lshl_or_b32 v21, v21, 15, v21
    v_and_b32 v21, 0x10001, v21
    v_bfe_u32 v22, v31, 16, 2
    v_lshl_or_b32 v22, v22, 15, v22
    v_and_b32 v22, 0x10001, v22
    v_bfe_u32 v23, v31, 18, 2
    v_lshl_or_b32 v23, v23, 15, v23
    v_and_b32 v23, 0x10001, v23
    v_lshlrev_b32 v31, 27, v28
    v_lshrrev_b32 v31, v29, v31
    v_bfe_u32 v24, v31, 0, 2
    v_lshl_or_b32 v24, v24, 15, v24
    v_and_b32 v24, 0x10001, v24
    v_bfe_u32 v25, v31, 2, 2
    v_lshl_or_b32 v25, v25, 15, v25
    v_and_b32 v25, 0x10001, v25
    v_bfe_u32 v26, v31, 16, 2
    v_lshl_or_b32 v26, v26, 15, v26
    v_and_b32 v26, 0x10001, v26
    v_bfe_u32 v27, v31, 18, 2
    v_lshl_or_b32 v27, v27, 15, v27
    v_and_b32 v27, 0x10001, v27
    s_waitcnt lgkmcnt(0)
    v_mul_u32_u24 v16, v30, v16
    v_mul_u32_u24 v17, v30, v17
    v_mul_u32_u24 v18, v30, v18
    v_mul_u32_u24 v19, v30, v19
    v_mul_u32_u24 v20, v30, v20
    v_mul_u32_u24 v21, v30, v21
    v_mul_u32_u24 v22, v30, v22
    v_mul_u32_u24 v23, v30, v23
    v_mul_u32_u24 v24, v30, v24
    v_mul_u32_u24 v25, v30, v25
    v_mul_u32_u24 v26, v30, v26
    v_mul_u32_u24 v27, v30, v27
    s_nop 1
L_spin6:
    ds_read_b32 v8, v9 offset:128
    s_waitcnt lgkmcnt(0)
    v_readfirstlane_b32 s59, v8
    s_sleep 2
    s_cmp_lt_u32 s59, 2
    s_nop 1
    s_cbranch_scc1 L_spin6
    ds_write_b128 v10, v[16:19]
    ds_write_b128 v10, v[20:23] offset:1024
    ds_write_b128 v10, v[24:27] offset:2048
    s_mov_b32 exec_lo, 1
    s_mov_b32 exec_hi, 0
    ds_add_u32 v9, v15 offset:144
    s_mov_b64 exec, -1
    s_branch L_end
L_roleC:
    s_setprio 2
    s_add_u32 s60, s48, 36864
    s_add_u32 s61, s46, 4992
    s_add_u32 s62, s46, 7296
    v_add_u32 v10, 1824, v11
    v_add_u32 v11, 1200, v11
    ds_read2_b32 v[32:33], v11 offset0:15 offset1:16
    ds_read2_b32 v[34:35], v11 offset0:23 offset1:24
    ds_read2_b32 v[36:37], v11 offset0:31 offset1:32
    ds_read2_b32 v[38:39], v11 offset0:39 offset1:40
    ds_read2_b32 v[40:41], v11 offset0:47 offset1:48
    ds_read2_b32 v[42:43], v11 offset0:67 offset1:68
    ds_read2_b32 v[44:45], v11 offset0:75 offset1:76
    ds_read2_b32 v[46:47], v11 offset0:83 offset1:84
    ds_read2_b32 v[48:49], v11 offset0:91 offset1:92
    ds_read2_b32 v[50:51], v11 offset0:99 offset1:100
    ds_read2_b32 v[52:53], v11 offset0:119 offset1:120
    ds_read2_b32 v[54:55], v11 offset0:127 offset1:128
    v_lshrrev_b32 v15, 1, v8
    v_mul_u32_u24 v15, 144, v15
    v_and_b32_e64 v16, 1, v8
    v_lshl_add_u32 v15, v16, 6, v15
    v_lshl_add_u32 v15, v9, 4, v15
    v_mov_b32 v18, 158208
    v_mov_b32_e64 v19, 1
    v_bfe_u32 v22, v1, 2, 2
    v_lshl_add_u32 v22, v9, 2, v22
    v_and_b32 v23, 3, v1
    v_lshlrev_b32 v23, 2, v23
    v_add_u32 v23, 256, v23
    v_lshl_add_u32 v4, v22, 4, v23
    v_subrev_u32_e64 v6, 8, v4
    v_bfe_u32 v20, v4, 2, 2
    v_bfe_u32 v21, v4, 6, 2
    v_xor_b32 v20, v20, v21
    v_lshrrev_b32 v21, 4, v4
    v_lshlrev_b32_e64 v21, 5, v21
    v_lshl_add_u32 v13, v20, 3, v21
    v_bfe_u32 v20, v6, 2, 2
    v_bfe_u32 v21, v6, 6, 2
    v_xor_b32 v20, v20, v21
    v_lshrrev_b32 v21, 4, v6
    v_lshlrev_b32_e64 v21, 5, v21
    v_lshl_add_u32 v14, v20, 3, v21
    s_lshl_b32 s49, s6, 11
    s_add_u32 s49, s49, 45568
    v_add_u32 v12, s49, v13
    v_add_u32 v13, s47, v13
    v_add_u32 v14, s47, v14
    v_lshl_add_u32 v17, s6, 2, v18
    s_waitcnt lgkmcnt(4)
    ds_read2_b32 v[56:57], v11 offset0:135 offset1:136
    ds_read2_b32 v[58:59], v11 offset0:143 offset1:144
    ds_read2_b32 v[60:61], v11 offset0:151 offset1:152
    ds_read2_b32 v[62:63], v10 offset0:15 offset1:16
    ds_read2_b32 v[64:65], v10 offset0:23 offset1:24
    ds_read2_b32 v[66:67], v10 offset0:31 offset1:32
    ds_read2_b32 v[68:69], v10 offset0:39 offset1:40
    ds_read2_b32 v[70:71], v10 offset0:47 offset1:48
    ds_read2_b32 v[72:73], v10 offset0:67 offset1:68
    ds_read2_b32 v[74:75], v10 offset0:75 offset1:76
    s_waitcnt lgkmcnt(4)
    ds_read2_b32 v[76:77], v10 offset0:83 offset1:84
    ds_read2_b32 v[78:79], v10 offset0:91 offset1:92
    ds_read2_b32 v[80:81], v10 offset0:99 offset1:100
    ds_read2_b32 v[82:83], v10 offset0:119 offset1:120
    ds_read2_b32 v[84:85], v10 offset0:127 offset1:128
    ds_read2_b32 v[86:87], v10 offset0:135 offset1:136
    ds_read2_b32 v[88:89], v10 offset0:143 offset1:144
    ds_read2_b32 v[90:91], v10 offset0:151 offset1:152
    s_waitcnt lgkmcnt(0)
    s_mov_b32 exec_lo, 1
    s_mov_b32 exec_hi, 0
    ds_add_u32 v17, v19 offset:128
    s_mov_b64 exec, -1
L_spin7:
    ds_read_b32 v16, v17 offset:224
    s_waitcnt lgkmcnt(0)
    v_readfirstlane_b32 s59, v16
    s_sleep 1
    s_cmp_lt_u32 s59, 1
    s_nop 1
    s_cbranch_scc1 L_spin7
    ds_read_b64_tr_b16 v[92:93], v13 offset:7104
    ds_read_b64_tr_b16 v[94:95], v13 offset:7616
    ds_read_b64_tr_b16 v[96:97], v13 offset:10208
    ds_read_b64_tr_b16 v[98:99], v13 offset:10720
    ds_read_b64_tr_b16 v[100:101], v14 offset:7104
    ds_read_b64_tr_b16 v[102:103], v14 offset:7616
    ds_read_b64_tr_b16 v[104:105], v14 offset:10208
    ds_read_b64_tr_b16 v[106:107], v14 offset:10720
    ds_read_b64_tr_b16 v[108:109], v13 offset:8128
    ds_read_b64_tr_b16 v[110:111], v13 offset:8640
    ds_read_b64_tr_b16 v[112:113], v13 offset:7104
    ds_read_b64_tr_b16 v[114:115], v13 offset:7616
    s_waitcnt lgkmcnt(10)
    v_mfma_f32_16x16x32_f16 v[8:11], v[92:95], v[38:41], 0
    v_mfma_f32_16x16x32_f16 v[20:23], v[92:95], v[36:39], 0
    ds_read_b64_tr_b16 v[116:117], v13 offset:11232
    ds_read_b64_tr_b16 v[118:119], v13 offset:11744
    s_waitcnt lgkmcnt(10)
    v_mfma_f32_16x16x32_f16 v[8:11], v[96:99], v[48:51], v[8:11]
    v_mfma_f32_16x16x32_f16 v[20:23], v[96:99], v[46:49], v[20:23]
    ds_read_b64_tr_b16 v[92:93], v13 offset:10208
    ds_read_b64_tr_b16 v[94:95], v13 offset:10720
    s_waitcnt lgkmcnt(10)
    v_mfma_f32_16x16x32_f16 v[8:11], v[100:103], v[58:61], v[8:11]
    v_mfma_f32_16x16x32_f16 v[20:23], v[100:103], v[56:59], v[20:23]
    ds_read_b64_tr_b16 v[96:97], v14 offset:8128
    ds_read_b64_tr_b16 v[98:99], v14 offset:8640
    s_waitcnt lgkmcnt(10)
    v_mfma_f32_16x16x32_f16 v[8:11], v[104:107], v[68:71], v[8:11]
    v_mfma_f32_16x16x32_f16 v[20:23], v[104:107], v[66:69], v[20:23]
    v_add_u32 v16, s60, v15
    s_nop 5
    ds_write_b128 v16, v[8:11]
    ds_write_b128 v16, v[20:23] offset:1152
    s_mov_b32 exec_lo, 1
    s_mov_b32 exec_hi, 0
    ds_add_u32 v18, v19 offset:196
    s_mov_b64 exec, -1
    s_setprio 1
    ds_read_b64_tr_b16 v[100:101], v14 offset:7104
    ds_read_b64_tr_b16 v[102:103], v14 offset:7616
    s_waitcnt lgkmcnt(13)
    v_mfma_f32_16x16x32_f16 v[8:11], v[108:111], v[38:41], 0
    v_mfma_f32_16x16x32_f16 v[20:23], v[108:111], v[36:39], 0
    ds_read_b64_tr_b16 v[104:105], v14 offset:11232
    ds_read_b64_tr_b16 v[106:107], v14 offset:11744
    s_waitcnt lgkmcnt(13)
    v_mfma_f32_16x16x32_f16 v[8:11], v[112:115], v[34:37], v[8:11]
    v_mfma_f32_16x16x32_f16 v[20:23], v[112:115], v[32:35], v[20:23]
    ds_read_b64_tr_b16 v[108:109], v14 offset:10208
    ds_read_b64_tr_b16 v[110:111], v14 offset:10720
    s_waitcnt lgkmcnt(13)
    v_mfma_f32_16x16x32_f16 v[8:11], v[116:119], v[48:51], v[8:11]
    v_mfma_f32_16x16x32_f16 v[20:23], v[116:119], v[46:49], v[20:23]
    ds_read_b64_tr_b16 v[112:113], v13 offset:13280
    ds_read_b64_tr_b16 v[114:115], v13 offset:13792
    s_waitcnt lgkmcnt(13)
    v_mfma_f32_16x16x32_f16 v[8:11], v[92:95], v[44:47], v[8:11]
    v_mfma_f32_16x16x32_f16 v[20:23], v[92:95], v[42:45], v[20:23]
    ds_read_b64_tr_b16 v[116:117], v12 offset:0
    ds_read_b64_tr_b16 v[118:119], v12 offset:512
    s_waitcnt lgkmcnt(13)
    v_mfma_f32_16x16x32_f16 v[8:11], v[96:99], v[58:61], v[8:11]
    v_mfma_f32_16x16x32_f16 v[20:23], v[96:99], v[56:59], v[20:23]
    ds_read_b64_tr_b16 v[92:93], v13 offset:9152
    ds_read_b64_tr_b16 v[94:95], v13 offset:9664
    s_waitcnt lgkmcnt(10)
    v_mfma_f32_16x16x32_f16 v[8:11], v[100:103], v[54:57], v[8:11]
    v_mfma_f32_16x16x32_f16 v[20:23], v[100:103], v[52:55], v[20:23]
    ds_read_b64_tr_b16 v[96:97], v13 offset:8128
    ds_read_b64_tr_b16 v[98:99], v13 offset:8640
    s_waitcnt lgkmcnt(10)
    v_mfma_f32_16x16x32_f16 v[8:11], v[104:107], v[68:71], v[8:11]
    v_mfma_f32_16x16x32_f16 v[20:23], v[104:107], v[66:69], v[20:23]
    ds_read_b64_tr_b16 v[100:101], v13 offset:12256
    ds_read_b64_tr_b16 v[102:103], v13 offset:12768
    s_waitcnt lgkmcnt(10)
    v_mfma_f32_16x16x32_f16 v[8:11], v[108:111], v[64:67], v[8:11]
    v_mfma_f32_16x16x32_f16 v[20:23], v[108:111], v[62:65], v[20:23]
    ds_read_b64_tr_b16 v[104:105], v13 offset:11232
    ds_read_b64_tr_b16 v[106:107], v13 offset:11744
    s_waitcnt lgkmcnt(10)
    v_mfma_f32_16x16x32_f16 v[8:11], v[112:115], v[78:81], v[8:11]
    v_mfma_f32_16x16x32_f16 v[20:23], v[112:115], v[76:79], v[20:23]
    ds_read_b64_tr_b16 v[108:109], v14 offset:9152
    ds_read_b64_tr_b16 v[110:111], v14 offset:9664
    s_waitcnt lgkmcnt(10)
    v_mfma_f32_16x16x32_f16 v[8:11], v[116:119], v[88:91], v[8:11]
    v_mfma_f32_16x16x32_f16 v[20:23], v[116:119], v[86:89], v[20:23]
    v_add_u32 v16, s61, v15
    s_nop 5
    ds_write_b128 v16, v[8:11]
    ds_write_b128 v16, v[20:23] offset:1152
    s_mov_b32 exec_lo, 1
    s_mov_b32 exec_hi, 0
    ds_add_u32 v18, v19 offset:200
    s_mov_b64 exec, -1
    s_setprio 0
    ds_read_b64_tr_b16 v[112:113], v14 offset:8128
    ds_read_b64_tr_b16 v[114:115], v14 offset:8640
    s_waitcnt lgkmcnt(13)
    v_mfma_f32_16x16x32_f16 v[8:11], v[92:95], v[38:41], 0
    v_mfma_f32_16x16x32_f16 v[20:23], v[92:95], v[36:39], 0
    ds_read_b64_tr_b16 v[116:117], v14 offset:12256
    ds_read_b64_tr_b16 v[118:119], v14 offset:12768
    s_waitcnt lgkmcnt(13)
    v_mfma_f32_16x16x32_f16 v[8:11], v[96:99], v[34:37], v[8:11]
    v_mfma_f32_16x16x32_f16 v[20:23], v[96:99], v[32:35], v[20:23]
    ds_read_b64_tr_b16 v[92:93], v14 offset:11232
    ds_read_b64_tr_b16 v[94:95], v14 offset:11744
    s_waitcnt lgkmcnt(13)
    v_mfma_f32_16x16x32_f16 v[8:11], v[100:103], v[48:51], v[8:11]
    v_mfma_f32_16x16x32_f16 v[20:23], v[100:103], v[46:49], v[20:23]
    ds_read_b64_tr_b16 v[96:97], v13 offset:14304
    ds_read_b64_tr_b16 v[98:99], v13 offset:14816
    s_waitcnt lgkmcnt(13)
    v_mfma_f32_16x16x32_f16 v[8:11], v[104:107], v[44:47], v[8:11]
    v_mfma_f32_16x16x32_f16 v[20:23], v[104:107], v[42:45], v[20:23]
    ds_read_b64_tr_b16 v[100:101], v13 offset:13280
    ds_read_b64_tr_b16 v[102:103], v13 offset:13792
    s_waitcnt lgkmcnt(13)
    v_mfma_f32_16x16x32_f16 v[8:11], v[108:111], v[58:61], v[8:11]
    v_mfma_f32_16x16x32_f16 v[20:23], v[108:111], v[56:59], v[20:23]
    ds_read_b64_tr_b16 v[104:105], v12 offset:1024
    ds_read_b64_tr_b16 v[106:107], v12 offset:1536
    s_waitcnt lgkmcnt(10)
    v_mfma_f32_16x16x32_f16 v[8:11], v[112:115], v[54:57], v[8:11]
    v_mfma_f32_16x16x32_f16 v[20:23], v[112:115], v[52:55], v[20:23]
    ds_read_b64_tr_b16 v[108:109], v12 offset:0
    ds_read_b64_tr_b16 v[110:111], v12 offset:512
    s_waitcnt lgkmcnt(10)
    v_mfma_f32_16x16x32_f16 v[8:11], v[116:119], v[68:71], v[8:11]
    v_mfma_f32_16x16x32_f16 v[20:23], v[116:119], v[66:69], v[20:23]
    s_waitcnt lgkmcnt(8)
    v_mfma_f32_16x16x32_f16 v[8:11], v[92:95], v[64:67], v[8:11]
    v_mfma_f32_16x16x32_f16 v[20:23], v[92:95], v[62:65], v[20:23]
    s_waitcnt lgkmcnt(6)
    v_mfma_f32_16x16x32_f16 v[8:11], v[96:99], v[78:81], v[8:11]
    v_mfma_f32_16x16x32_f16 v[20:23], v[96:99], v[76:79], v[20:23]
    s_waitcnt lgkmcnt(4)
    v_mfma_f32_16x16x32_f16 v[8:11], v[100:103], v[74:77], v[8:11]
    v_mfma_f32_16x16x32_f16 v[20:23], v[100:103], v[72:75], v[20:23]
    s_waitcnt lgkmcnt(2)
    v_mfma_f32_16x16x32_f16 v[8:11], v[104:107], v[88:91], v[8:11]
    v_mfma_f32_16x16x32_f16 v[20:23], v[104:107], v[86:89], v[20:23]
    s_waitcnt lgkmcnt(0)
    v_mfma_f32_16x16x32_f16 v[8:11], v[108:111], v[84:87], v[8:11]
    v_mfma_f32_16x16x32_f16 v[20:23], v[108:111], v[82:85], v[20:23]
    v_add_u32 v16, s62, v15
    s_nop 5
    ds_write_b128 v16, v[8:11]
    ds_write_b128 v16, v[20:23] offset:1152
    s_mov_b32 exec_lo, 1
    s_mov_b32 exec_hi, 0
    ds_add_u32 v18, v19 offset:204
    s_mov_b64 exec, -1
    s_branch L_end
L_acc0:
    v_mov_b32 v4, 0
    v_mov_b32 v5, 0
    v_mov_b32 v6, 0
    v_mov_b32 v7, 0
    v_mov_b32 v16, 0
    v_mov_b32 v17, 0
    v_mov_b32 v18, 0
    v_mov_b32 v19, 0
    v_mov_b32 v28, 0
    v_mov_b32 v29, 0
    v_mov_b32 v30, 0
    v_mov_b32 v31, 0
    s_nop 0
    s_branch L_accdone
L_gs_fixg:
    ds_read_b32 v8, v9 offset:144
    s_waitcnt lgkmcnt(0)
    v_readfirstlane_b32 s59, v8
    s_cmp_lt_u32 s59, 1
    s_nop 2
    s_cbranch_scc1 L_gs_fixg
    s_branch L_gr_fixg
L_end:
    s_endpgm
L_codeend:
.section .rodata,"a"
.p2align 6
.amdhsa_kernel standalone__ssm_conv_s4d__prompt_kernel
  .amdhsa_next_free_vgpr 128
  .amdhsa_next_free_sgpr 96
  .amdhsa_accum_offset 128
  .amdhsa_group_segment_fixed_size 0
  .amdhsa_kernarg_size 80
  .amdhsa_user_sgpr_count 2
  .amdhsa_user_sgpr_kernarg_segment_ptr 1
  .amdhsa_system_sgpr_workgroup_id_x 1
.end_amdhsa_kernel
```
